```python
import torch

def _softmax(x, axis=-1):
    return torch.softmax(x, dim=axis)
def _gelu(x):
    return torch.nn.functional.gelu(x, approximate="tanh")
def _silu(x):
    return torch.nn.functional.silu(x)
def _sigmoid(x):
    return torch.sigmoid(x)
def _layernorm(x, axis=-1, eps=1e-5):
    m = x.mean(dim=axis, keepdim=True)
    v = x.var(dim=axis, keepdim=True, unbiased=False)
    return (x - m) / torch.sqrt(v + eps)
def _scatter_add(tgt, idx, src, axis=0):
    return tgt.clone().index_add_(axis, idx, src)
def _segment_sum(src, seg, n):
    out = torch.zeros((n,) + src.shape[1:], dtype=src.dtype)
    return out.index_add_(0, seg, src)
def _pad(x, pw):
    flat = tuple(v for pair in reversed(pw) for v in pair)
    return torch.nn.functional.pad(x, flat)

kernel_name = 'recurrent_scan__compressed_kv_cla__dense_activation_mish__prompt'

def setup_inputs():

    _w = (lambda a: (lambda t: t.to(torch.bfloat16) if t.is_floating_point() else t)(torch.as_tensor(a)))
    def _A_setup():
        B, H, Sq, Sk, D, M = 1, 16, 2048, 2048, 256, 448
        Dc = 4 * D
        return {
            "x": _w((lambda *s: torch.randn(*s, dtype=torch.bfloat16) * 0.05)(B, Sq, M)),
            "c_kv": _w((lambda *s: torch.randn(*s, dtype=torch.bfloat16) * 0.8)(B, Sk, Dc)),
            "w_q": _w((lambda *s: torch.randn(*s, dtype=torch.bfloat16) * 1.6)(M, H, D) * (M ** -0.5)),
            "w_uk": _w((lambda *s: torch.randn(*s, dtype=torch.bfloat16) * 1.6)(Dc, H, D) * (Dc ** -0.5)),
            "w_uv": _w((lambda *s: torch.randn(*s, dtype=torch.bfloat16) * 0.8)(Dc, H, D) * (Dc ** -0.5)),
            "w_o": _w((lambda *s: torch.randn(*s, dtype=torch.bfloat16) * 0.8)(H, D, M) * ((H * D) ** -0.5)),
        }
    _A_in = _A_setup()

    def _B_setup():
        B, S, D, F = 1, 2048, 448, 1792
        return {
            "x": _w((lambda *s: torch.randn(*s, dtype=torch.bfloat16) * 0.05)(B, S, D)),
            "w1": _w((lambda *s: torch.randn(*s, dtype=torch.bfloat16) * 0.8)(D, F) * (D ** -0.5)),
            "b1": _w((lambda *s: torch.randn(*s, dtype=torch.bfloat16) * 0.8)(F)),
            "w2": _w((lambda *s: torch.randn(*s, dtype=torch.bfloat16) * 0.2)(F, D) * (F ** -0.5)),
        }
    _B_in = _B_setup()

    return {
        "A_x": _A_in["x"],
        "A_c_kv": _A_in["c_kv"],
        "A_w_q": _A_in["w_q"],
        "A_w_uk": _A_in["w_uk"],
        "A_w_uv": _A_in["w_uv"],
        "A_w_o": _A_in["w_o"],
        "B_x": _B_in["x"],
        "B_w1": _B_in["w1"],
        "B_b1": _B_in["b1"],
        "B_w2": _B_in["w2"],
    }

def reference(A_x, A_c_kv, A_w_q, A_w_uk, A_w_uv, A_w_o, B_x, B_w1, B_b1, B_w2):
    def _A_ref(x, c_kv, w_q, w_uk, w_uv, w_o):
        B, Sq, M = x.shape[0], x.shape[1], x.shape[2]
        Sk = c_kv.shape[1]
        H, D = w_q.shape[1], w_q.shape[2]
        q = torch.einsum("bqm,mhd->bhqd", x, w_q)
        k = torch.einsum("bkc,chd->bhkd", c_kv, w_uk)
        v = torch.einsum("bkc,chd->bhkd", c_kv, w_uv)
        scores = torch.einsum("bhqd,bhkd->bhqk", q, k) * (D ** -0.5)
        off = Sk - Sq
        qi = torch.arange(Sq)[:, None]
        kj = torch.arange(Sk)[None, :]
        cmask = kj <= (qi + off)
        scores = torch.where(cmask[None, None], scores, -1e9)
        p = _softmax(scores, axis=-1)
        ctx = torch.einsum("bhqk,bhkd->bhqd", p, v)
        return torch.einsum("bhqd,hdm->bqm", ctx, w_o)

    def _B_ref(x, w1, b1, w2):
        h = torch.einsum("bsd,df->bsf", x, w1) + b1
        sp = torch.log1p(torch.exp(-torch.abs(h))) + torch.where(h > 0, h, torch.zeros_like(h))
        act = h * torch.tanh(sp)
        return torch.einsum("bsf,fd->bsd", act, w2)

    x = A_x
    xn = _layernorm(x, axis=-1)
    s = _A_ref(xn, A_c_kv, A_w_q, A_w_uk, A_w_uv, A_w_o)
    g = _silu(_B_ref(xn, B_w1, B_b1, B_w2))
    return x + s * g
```

```asm
; @launch kernel=ln_kernel grid=(512,1,1) block=(256,1,1) lds=0
; @launch kernel=proj_kernel grid=(440,1,1) block=(512,1,1) lds=131072
; @launch kernel=attn_kernel grid=(256,1,1) block=(256,1,1) lds=131072
; @launch kernel=out_kernel grid=(224,1,1) block=(256,1,1) lds=98304
.amdgcn_target "amdgcn-amd-amdhsa--gfx950"
.text
.globl ln_kernel
.p2align 8
.type ln_kernel,@function
ln_kernel:

    s_cmp_ge_u32 s2, 512
    s_cbranch_scc1 ln_done
    s_load_dwordx2 s[4:5], s[0:1], 0
    s_load_dwordx2 s[6:7], s[0:1], 96
    v_and_b32 v1, 63, v0
    v_lshrrev_b32 v2, 6, v0
    s_lshl_b32 s3, s2, 2
    v_add_u32 v2, s3, v2
    s_mov_b32 s3, 896
    v_mul_lo_u32 v3, v2, s3
    v_lshl_add_u32 v3, v1, 4, v3
    s_waitcnt lgkmcnt(0)
    s_mov_b32 s8, s4
    s_mov_b32 s9, s5
    s_mov_b32 s10, 1835008
    s_mov_b32 s11, 0x20000
    s_add_u32 s12, s6, 0
    s_addc_u32 s13, s7, 0
    s_mov_b32 s14, 1835008
    s_mov_b32 s15, 0x20000
    v_mov_b32 v4, 0
    v_mov_b32 v5, 0
    v_mov_b32 v6, 0
    v_mov_b32 v7, 0
    v_cmp_gt_u32 vcc, 56, v1
    s_and_saveexec_b64 s[16:17], vcc
    buffer_load_dwordx4 v[4:7], v3, s[8:11], 0 offen
    s_mov_b64 exec, s[16:17]
    s_waitcnt vmcnt(0)

    v_lshlrev_b32 v10, 16, v4
    v_and_b32 v11, 0xffff0000, v4
    v_lshlrev_b32 v12, 16, v5
    v_and_b32 v13, 0xffff0000, v5
    v_lshlrev_b32 v14, 16, v6
    v_and_b32 v15, 0xffff0000, v6
    v_lshlrev_b32 v16, 16, v7
    v_and_b32 v17, 0xffff0000, v7
    v_add_f32 v20, v10, v11
    v_add_f32 v20, v20, v12
    v_add_f32 v20, v20, v13
    v_add_f32 v20, v20, v14
    v_add_f32 v20, v20, v15
    v_add_f32 v20, v20, v16
    v_add_f32 v20, v20, v17
    ds_swizzle_b32 v21, v20 offset:0x41f
    s_waitcnt lgkmcnt(0)
    v_add_f32 v20, v20, v21
    ds_swizzle_b32 v21, v20 offset:0x81f
    s_waitcnt lgkmcnt(0)
    v_add_f32 v20, v20, v21
    ds_swizzle_b32 v21, v20 offset:0x101f
    s_waitcnt lgkmcnt(0)
    v_add_f32 v20, v20, v21
    ds_swizzle_b32 v21, v20 offset:0x201f
    s_waitcnt lgkmcnt(0)
    v_add_f32 v20, v20, v21
    ds_swizzle_b32 v21, v20 offset:0x401f
    s_waitcnt lgkmcnt(0)
    v_add_f32 v20, v20, v21
    v_mov_b32 v21, v20
    s_nop 1
    v_permlane32_swap_b32 v20, v21
    s_nop 1
    v_add_f32 v20, v20, v21
    v_mul_f32 v20, 0.002232142857142857, v20
    v_mov_b32 v22, 0

    v_cmp_gt_u32 vcc, 56, v1
    v_sub_f32 v23, v10, v20
    v_fmac_f32 v22, v23, v23
    v_sub_f32 v23, v11, v20
    v_fmac_f32 v22, v23, v23
    v_sub_f32 v23, v12, v20
    v_fmac_f32 v22, v23, v23
    v_sub_f32 v23, v13, v20
    v_fmac_f32 v22, v23, v23
    v_sub_f32 v23, v14, v20
    v_fmac_f32 v22, v23, v23
    v_sub_f32 v23, v15, v20
    v_fmac_f32 v22, v23, v23
    v_sub_f32 v23, v16, v20
    v_fmac_f32 v22, v23, v23
    v_sub_f32 v23, v17, v20
    v_fmac_f32 v22, v23, v23
    v_cndmask_b32 v22, 0, v22, vcc
    ds_swizzle_b32 v21, v22 offset:0x41f
    s_waitcnt lgkmcnt(0)
    v_add_f32 v22, v22, v21
    ds_swizzle_b32 v21, v22 offset:0x81f
    s_waitcnt lgkmcnt(0)
    v_add_f32 v22, v22, v21
    ds_swizzle_b32 v21, v22 offset:0x101f
    s_waitcnt lgkmcnt(0)
    v_add_f32 v22, v22, v21
    ds_swizzle_b32 v21, v22 offset:0x201f
    s_waitcnt lgkmcnt(0)
    v_add_f32 v22, v22, v21
    ds_swizzle_b32 v21, v22 offset:0x401f
    s_waitcnt lgkmcnt(0)
    v_add_f32 v22, v22, v21
    v_mov_b32 v21, v22
    s_nop 1
    v_permlane32_swap_b32 v22, v21
    s_nop 1
    v_add_f32 v22, v22, v21
    v_mul_f32 v22, 0.002232142857142857, v22
    v_cvt_pk_bf16_f32 v24, v20, v22
    v_lshlrev_b32 v25, 16, v24
    v_and_b32 v26, 0xffff0000, v24
    v_add_f32 v26, 1e-05, v26
    v_cvt_pk_bf16_f32 v26, v26, v26
    v_lshlrev_b32 v26, 16, v26
    v_sqrt_f32 v26, v26
    s_nop 0
    v_cvt_pk_bf16_f32 v26, v26, v26
    v_lshlrev_b32 v26, 16, v26
    v_rcp_f32 v27, v26
    s_nop 0

    v_sub_f32 v28, v10, v25
    v_sub_f32 v29, v11, v25
    v_cvt_pk_bf16_f32 v30, v28, v29
    v_lshlrev_b32 v28, 16, v30
    v_and_b32 v29, 0xffff0000, v30
    v_mul_f32 v28, v28, v27
    v_mul_f32 v29, v29, v27
    v_cvt_pk_bf16_f32 v4, v28, v29
    v_sub_f32 v28, v12, v25
    v_sub_f32 v29, v13, v25
    v_cvt_pk_bf16_f32 v30, v28, v29
    v_lshlrev_b32 v28, 16, v30
    v_and_b32 v29, 0xffff0000, v30
    v_mul_f32 v28, v28, v27
    v_mul_f32 v29, v29, v27
    v_cvt_pk_bf16_f32 v5, v28, v29
    v_sub_f32 v28, v14, v25
    v_sub_f32 v29, v15, v25
    v_cvt_pk_bf16_f32 v30, v28, v29
    v_lshlrev_b32 v28, 16, v30
    v_and_b32 v29, 0xffff0000, v30
    v_mul_f32 v28, v28, v27
    v_mul_f32 v29, v29, v27
    v_cvt_pk_bf16_f32 v6, v28, v29
    v_sub_f32 v28, v16, v25
    v_sub_f32 v29, v17, v25
    v_cvt_pk_bf16_f32 v30, v28, v29
    v_lshlrev_b32 v28, 16, v30
    v_and_b32 v29, 0xffff0000, v30
    v_mul_f32 v28, v28, v27
    v_mul_f32 v29, v29, v27
    v_cvt_pk_bf16_f32 v7, v28, v29
    v_cmp_gt_u32 vcc, 56, v1
    s_and_saveexec_b64 s[16:17], vcc
    buffer_store_dwordx4 v[4:7], v3, s[12:15], 0 offen
    s_mov_b64 exec, s[16:17]

ln_done:
    s_endpgm

.globl proj_kernel
.p2align 8
.type proj_kernel,@function
proj_kernel:

    s_cmp_ge_u32 s2, 440
    s_cbranch_scc1 pj_done
    s_load_dwordx2 s[4:5], s[0:1], 96
    s_load_dwordx2 s[6:7], s[0:1], 8
    s_load_dwordx2 s[26:27], s[0:1], 24
    s_load_dwordx2 s[28:29], s[0:1], 32
    s_load_dwordx2 s[30:31], s[0:1], 16
    s_load_dwordx2 s[32:33], s[0:1], 56
    s_load_dwordx2 s[34:35], s[0:1], 64
    v_lshrrev_b32 v1, 6, v0
    s_nop 0
    v_readfirstlane_b32 s24, v1
    s_waitcnt lgkmcnt(0)
    s_lshr_b32 s3, s2, 7
    s_and_b32 s36, s2, 127
    s_cmp_eq_u32 s3, 3
    s_cselect_b32 s37, 384, 0
    s_sub_u32 s37, s2, s37
    s_cselect_b32 s36, s37, s36
    s_and_b32 s38, s36, 7
    s_lshr_b32 s39, s36, 3
    s_mov_b32 s8, s6
    s_mov_b32 s9, s7
    s_mov_b32 s10, 4194304
    s_mov_b32 s11, 0x20000
    s_mov_b32 s40, 2048
    s_mov_b32 s41, 8192
    s_mov_b32 s42, 16
    s_mov_b32 s12, s26
    s_mov_b32 s13, s27
    s_mov_b32 s14, 8388608
    s_mov_b32 s15, 0x20000
    s_mov_b32 s43, 18874368
    s_mov_b32 s44, 512
    s_cmp_eq_u32 s3, 0
    s_cbranch_scc1 pj_setup_done
    s_cmp_eq_u32 s3, 1
    s_cbranch_scc0 pj_not_v
    s_mov_b32 s12, s28
    s_mov_b32 s13, s29
    s_mov_b32 s43, 35651584
    s_branch pj_setup_done

pj_not_v:
    s_add_u32 s8, s4, 0
    s_addc_u32 s9, s5, 0
    s_mov_b32 s10, 1835008
    s_mov_b32 s40, 896
    s_mov_b32 s42, 7
    s_cmp_eq_u32 s3, 2
    s_cbranch_scc0 pj_is_h
    s_mov_b32 s12, s30
    s_mov_b32 s13, s31
    s_mov_b32 s14, 3670016
    s_mov_b32 s43, 2097152
    s_branch pj_setup_done

pj_is_h:
    s_mov_b32 s12, s32
    s_mov_b32 s13, s33
    s_mov_b32 s14, 1605632
    s_mov_b32 s41, 3584
    s_mov_b32 s43, 52428800
    s_mov_b32 s44, 3584

pj_setup_done:
    s_lshl_b32 s45, s39, 20
    s_cmp_eq_u32 s3, 3
    s_cselect_b32 s45, 0, s45
    s_add_u32 s43, s43, s45
    s_add_u32 s16, s4, s43
    s_addc_u32 s17, s5, 0
    s_mov_b32 s18, 7340032
    s_cmp_eq_u32 s3, 3
    s_cselect_b32 s18, s18, 1048576
    s_mov_b32 s19, 0x20000
    s_lshl_b32 s46, s38, 8
    s_lshl_b32 s47, s39, 8
    v_and_b32 v2, 63, v0

    s_lshl_b32 s48, s24, 2
    s_add_u32 s48, s48, 0
    v_lshrrev_b32 v3, 3, v2
    s_lshl_b32 s49, s48, 3
    v_add_u32 v3, s49, v3
    v_lshrrev_b32 v4, 1, v3
    v_and_b32 v4, 7, v4
    v_and_b32 v5, 7, v2
    v_xor_b32 v4, v4, v5
    v_add_u32 v3, s46, v3
    v_mul_lo_u32 v3, v3, s40
    v_lshl_add_u32 v24, v4, 4, v3
    v_lshrrev_b32 v3, 5, v2
    s_lshl_b32 s49, s48, 1
    v_add_u32 v3, s49, v3
    v_and_b32 v4, 3, v3
    v_lshlrev_b32 v4, 2, v4
    v_and_b32 v5, 31, v2
    v_xor_b32 v4, v4, v5
    v_mul_lo_u32 v3, v3, s41
    v_lshl_add_u32 v3, v4, 4, v3
    s_lshl_b32 s49, s47, 1
    v_add_u32 v28, s49, v3

    s_lshl_b32 s48, s24, 2
    s_add_u32 s48, s48, 1
    v_lshrrev_b32 v3, 3, v2
    s_lshl_b32 s49, s48, 3
    v_add_u32 v3, s49, v3
    v_lshrrev_b32 v4, 1, v3
    v_and_b32 v4, 7, v4
    v_and_b32 v5, 7, v2
    v_xor_b32 v4, v4, v5
    v_add_u32 v3, s46, v3
    v_mul_lo_u32 v3, v3, s40
    v_lshl_add_u32 v25, v4, 4, v3
    v_lshrrev_b32 v3, 5, v2
    s_lshl_b32 s49, s48, 1
    v_add_u32 v3, s49, v3
    v_and_b32 v4, 3, v3
    v_lshlrev_b32 v4, 2, v4
    v_and_b32 v5, 31, v2
    v_xor_b32 v4, v4, v5
    v_mul_lo_u32 v3, v3, s41
    v_lshl_add_u32 v3, v4, 4, v3
    s_lshl_b32 s49, s47, 1
    v_add_u32 v29, s49, v3

    s_lshl_b32 s48, s24, 2
    s_add_u32 s48, s48, 2
    v_lshrrev_b32 v3, 3, v2
    s_lshl_b32 s49, s48, 3
    v_add_u32 v3, s49, v3
    v_lshrrev_b32 v4, 1, v3
    v_and_b32 v4, 7, v4
    v_and_b32 v5, 7, v2
    v_xor_b32 v4, v4, v5
    v_add_u32 v3, s46, v3
    v_mul_lo_u32 v3, v3, s40
    v_lshl_add_u32 v26, v4, 4, v3
    v_lshrrev_b32 v3, 5, v2
    s_lshl_b32 s49, s48, 1
    v_add_u32 v3, s49, v3
    v_and_b32 v4, 3, v3
    v_lshlrev_b32 v4, 2, v4
    v_and_b32 v5, 31, v2
    v_xor_b32 v4, v4, v5
    v_mul_lo_u32 v3, v3, s41
    v_lshl_add_u32 v3, v4, 4, v3
    s_lshl_b32 s49, s47, 1
    v_add_u32 v30, s49, v3

    s_lshl_b32 s48, s24, 2
    s_add_u32 s48, s48, 3
    v_lshrrev_b32 v3, 3, v2
    s_lshl_b32 s49, s48, 3
    v_add_u32 v3, s49, v3
    v_lshrrev_b32 v4, 1, v3
    v_and_b32 v4, 7, v4
    v_and_b32 v5, 7, v2
    v_xor_b32 v4, v4, v5
    v_add_u32 v3, s46, v3
    v_mul_lo_u32 v3, v3, s40
    v_lshl_add_u32 v27, v4, 4, v3
    v_lshrrev_b32 v3, 5, v2
    s_lshl_b32 s49, s48, 1
    v_add_u32 v3, s49, v3
    v_and_b32 v4, 3, v3
    v_lshlrev_b32 v4, 2, v4
    v_and_b32 v5, 31, v2
    v_xor_b32 v4, v4, v5
    v_mul_lo_u32 v3, v3, s41
    v_lshl_add_u32 v3, v4, 4, v3
    s_lshl_b32 s49, s47, 1
    v_add_u32 v31, s49, v3

    s_and_b32 s50, s24, 3
    s_lshr_b32 s51, s24, 2
    v_and_b32 v3, 31, v2
    s_lshl_b32 s49, s51, 7
    v_add_u32 v3, s49, v3
    v_lshrrev_b32 v4, 1, v3
    v_and_b32 v4, 7, v4
    v_lshrrev_b32 v5, 5, v2
    v_lshlrev_b32 v3, 7, v3

    v_add_u32 v6, 0, v5
    v_xor_b32 v6, v6, v4
    v_lshl_add_u32 v10, v6, 4, v3
    v_add_u32 v14, 0x10000, v10

    v_add_u32 v6, 2, v5
    v_xor_b32 v6, v6, v4
    v_lshl_add_u32 v11, v6, 4, v3
    v_add_u32 v15, 0x10000, v11

    v_add_u32 v6, 4, v5
    v_xor_b32 v6, v6, v4
    v_lshl_add_u32 v12, v6, 4, v3
    v_add_u32 v16, 0x10000, v12

    v_add_u32 v6, 6, v5
    v_xor_b32 v6, v6, v4
    v_lshl_add_u32 v13, v6, 4, v3
    v_add_u32 v17, 0x10000, v13

    v_lshrrev_b32 v3, 5, v2
    v_lshlrev_b32 v3, 3, v3
    v_bfe_u32 v4, v2, 2, 2
    v_add_u32 v3, v3, v4
    v_lshlrev_b32 v3, 9, v3
    v_add_u32 v3, 0x8000, v3
    v_bfe_u32 v5, v2, 4, 1
    v_lshlrev_b32 v5, 1, v5
    v_bfe_u32 v6, v2, 1, 1
    v_add_u32 v5, v5, v6
    s_lshl_b32 s49, s50, 3
    v_add_u32 v5, s49, v5
    v_lshlrev_b32 v4, 2, v4
    v_and_b32 v7, 1, v2
    v_lshlrev_b32 v7, 3, v7
    v_xor_b32 v6, v5, v4
    v_lshl_add_u32 v6, v6, 4, v7
    v_add_u32 v18, v3, v6
    v_add_u32 v5, 4, v5
    v_xor_b32 v6, v5, v4
    v_lshl_add_u32 v6, v6, 4, v7
    v_add_u32 v19, v3, v6
    v_add_u32 v20, 0x10000, v18
    v_add_u32 v21, 0x10000, v19

    v_mov_b32 v64, 0
    v_mov_b32 v65, 0
    v_mov_b32 v66, 0
    v_mov_b32 v67, 0
    v_mov_b32 v68, 0
    v_mov_b32 v69, 0
    v_mov_b32 v70, 0
    v_mov_b32 v71, 0
    v_mov_b32 v72, 0
    v_mov_b32 v73, 0
    v_mov_b32 v74, 0
    v_mov_b32 v75, 0
    v_mov_b32 v76, 0
    v_mov_b32 v77, 0
    v_mov_b32 v78, 0
    v_mov_b32 v79, 0
    v_mov_b32 v80, 0
    v_mov_b32 v81, 0
    v_mov_b32 v82, 0
    v_mov_b32 v83, 0
    v_mov_b32 v84, 0
    v_mov_b32 v85, 0
    v_mov_b32 v86, 0
    v_mov_b32 v87, 0
    v_mov_b32 v88, 0
    v_mov_b32 v89, 0
    v_mov_b32 v90, 0
    v_mov_b32 v91, 0
    v_mov_b32 v92, 0
    v_mov_b32 v93, 0
    v_mov_b32 v94, 0
    v_mov_b32 v95, 0
    v_mov_b32 v96, 0
    v_mov_b32 v97, 0
    v_mov_b32 v98, 0
    v_mov_b32 v99, 0
    v_mov_b32 v100, 0
    v_mov_b32 v101, 0
    v_mov_b32 v102, 0
    v_mov_b32 v103, 0
    v_mov_b32 v104, 0
    v_mov_b32 v105, 0
    v_mov_b32 v106, 0
    v_mov_b32 v107, 0
    v_mov_b32 v108, 0
    v_mov_b32 v109, 0
    v_mov_b32 v110, 0
    v_mov_b32 v111, 0
    v_mov_b32 v112, 0
    v_mov_b32 v113, 0
    v_mov_b32 v114, 0
    v_mov_b32 v115, 0
    v_mov_b32 v116, 0
    v_mov_b32 v117, 0
    v_mov_b32 v118, 0
    v_mov_b32 v119, 0
    v_mov_b32 v120, 0
    v_mov_b32 v121, 0
    v_mov_b32 v122, 0
    v_mov_b32 v123, 0
    v_mov_b32 v124, 0
    v_mov_b32 v125, 0
    v_mov_b32 v126, 0
    v_mov_b32 v127, 0
    v_mov_b32 v128, 0
    v_mov_b32 v129, 0
    v_mov_b32 v130, 0
    v_mov_b32 v131, 0
    v_mov_b32 v132, 0
    v_mov_b32 v133, 0
    v_mov_b32 v134, 0
    v_mov_b32 v135, 0
    v_mov_b32 v136, 0
    v_mov_b32 v137, 0
    v_mov_b32 v138, 0
    v_mov_b32 v139, 0
    v_mov_b32 v140, 0
    v_mov_b32 v141, 0
    v_mov_b32 v142, 0
    v_mov_b32 v143, 0
    v_mov_b32 v144, 0
    v_mov_b32 v145, 0
    v_mov_b32 v146, 0
    v_mov_b32 v147, 0
    v_mov_b32 v148, 0
    v_mov_b32 v149, 0
    v_mov_b32 v150, 0
    v_mov_b32 v151, 0
    v_mov_b32 v152, 0
    v_mov_b32 v153, 0
    v_mov_b32 v154, 0
    v_mov_b32 v155, 0
    v_mov_b32 v156, 0
    v_mov_b32 v157, 0
    v_mov_b32 v158, 0
    v_mov_b32 v159, 0
    v_mov_b32 v160, 0
    v_mov_b32 v161, 0
    v_mov_b32 v162, 0
    v_mov_b32 v163, 0
    v_mov_b32 v164, 0
    v_mov_b32 v165, 0
    v_mov_b32 v166, 0
    v_mov_b32 v167, 0
    v_mov_b32 v168, 0
    v_mov_b32 v169, 0
    v_mov_b32 v170, 0
    v_mov_b32 v171, 0
    v_mov_b32 v172, 0
    v_mov_b32 v173, 0
    v_mov_b32 v174, 0
    v_mov_b32 v175, 0
    v_mov_b32 v176, 0
    v_mov_b32 v177, 0
    v_mov_b32 v178, 0
    v_mov_b32 v179, 0
    v_mov_b32 v180, 0
    v_mov_b32 v181, 0
    v_mov_b32 v182, 0
    v_mov_b32 v183, 0
    v_mov_b32 v184, 0
    v_mov_b32 v185, 0
    v_mov_b32 v186, 0
    v_mov_b32 v187, 0
    v_mov_b32 v188, 0
    v_mov_b32 v189, 0
    v_mov_b32 v190, 0
    v_mov_b32 v191, 0
    s_lshl_b32 s25, s24, 12
    s_mov_b32 s20, 0
    s_mov_b32 s21, 0
    s_lshl_b32 s52, s41, 6
    s_mov_b32 s22, 0

    s_add_u32 m0, s25, 0
    s_nop 0
    buffer_load_dwordx4 v24, s[8:11], s20 offen lds
    s_add_u32 m0, s25, 1024
    s_nop 0
    buffer_load_dwordx4 v25, s[8:11], s20 offen lds
    s_add_u32 m0, s25, 2048
    s_nop 0
    buffer_load_dwordx4 v26, s[8:11], s20 offen lds
    s_add_u32 m0, s25, 3072
    s_nop 0
    buffer_load_dwordx4 v27, s[8:11], s20 offen lds
    s_add_u32 m0, s25, 32768
    s_nop 0
    buffer_load_dwordx4 v28, s[12:15], s21 offen lds
    s_add_u32 m0, s25, 33792
    s_nop 0
    buffer_load_dwordx4 v29, s[12:15], s21 offen lds
    s_add_u32 m0, s25, 34816
    s_nop 0
    buffer_load_dwordx4 v30, s[12:15], s21 offen lds
    s_add_u32 m0, s25, 35840
    s_nop 0
    buffer_load_dwordx4 v31, s[12:15], s21 offen lds
    s_add_u32 s20, s20, 128
    s_add_u32 s21, s21, s52
pj_loop:
    s_waitcnt vmcnt(0)
    s_barrier
    s_add_u32 s22, s22, 1
    s_cmp_ge_u32 s22, s42
    s_cbranch_scc1 pj_nodma0
    s_add_u32 m0, s25, 65536
    s_nop 0
    buffer_load_dwordx4 v24, s[8:11], s20 offen lds
    s_add_u32 m0, s25, 66560
    s_nop 0
    buffer_load_dwordx4 v25, s[8:11], s20 offen lds
    s_add_u32 m0, s25, 67584
    s_nop 0
    buffer_load_dwordx4 v26, s[8:11], s20 offen lds
    s_add_u32 m0, s25, 68608
    s_nop 0
    buffer_load_dwordx4 v27, s[8:11], s20 offen lds
    s_add_u32 m0, s25, 98304
    s_nop 0
    buffer_load_dwordx4 v28, s[12:15], s21 offen lds
    s_add_u32 m0, s25, 99328
    s_nop 0
    buffer_load_dwordx4 v29, s[12:15], s21 offen lds
    s_add_u32 m0, s25, 100352
    s_nop 0
    buffer_load_dwordx4 v30, s[12:15], s21 offen lds
    s_add_u32 m0, s25, 101376
    s_nop 0
    buffer_load_dwordx4 v31, s[12:15], s21 offen lds
    s_add_u32 s20, s20, 128
    s_add_u32 s21, s21, s52
pj_nodma0:
    ds_read_b64_tr_b16 v[192:193], v18 offset:0
    ds_read_b64_tr_b16 v[194:195], v18 offset:2048
    ds_read_b64_tr_b16 v[196:197], v19 offset:0
    ds_read_b64_tr_b16 v[198:199], v19 offset:2048
    ds_read_b128 v[200:203], v10 offset:0
    ds_read_b128 v[204:207], v10 offset:4096
    ds_read_b128 v[208:211], v10 offset:8192
    ds_read_b128 v[212:215], v10 offset:12288
    ds_read_b64_tr_b16 v[216:217], v18 offset:8192
    ds_read_b64_tr_b16 v[218:219], v18 offset:10240
    ds_read_b64_tr_b16 v[220:221], v19 offset:8192
    ds_read_b64_tr_b16 v[222:223], v19 offset:10240
    ds_read_b128 v[224:227], v11 offset:0
    ds_read_b128 v[228:231], v11 offset:4096
    ds_read_b128 v[232:235], v11 offset:8192
    ds_read_b128 v[236:239], v11 offset:12288
    s_waitcnt lgkmcnt(8)
    v_mfma_f32_32x32x16_bf16 v[64:79], v[192:195], v[200:203], v[64:79]
    v_mfma_f32_32x32x16_bf16 v[80:95], v[192:195], v[204:207], v[80:95]
    v_mfma_f32_32x32x16_bf16 v[96:111], v[192:195], v[208:211], v[96:111]
    v_mfma_f32_32x32x16_bf16 v[112:127], v[192:195], v[212:215], v[112:127]
    v_mfma_f32_32x32x16_bf16 v[128:143], v[196:199], v[200:203], v[128:143]
    v_mfma_f32_32x32x16_bf16 v[144:159], v[196:199], v[204:207], v[144:159]
    v_mfma_f32_32x32x16_bf16 v[160:175], v[196:199], v[208:211], v[160:175]
    v_mfma_f32_32x32x16_bf16 v[176:191], v[196:199], v[212:215], v[176:191]
    ds_read_b64_tr_b16 v[192:193], v18 offset:16384
    ds_read_b64_tr_b16 v[194:195], v18 offset:18432
    ds_read_b64_tr_b16 v[196:197], v19 offset:16384
    ds_read_b64_tr_b16 v[198:199], v19 offset:18432
    ds_read_b128 v[200:203], v12 offset:0
    ds_read_b128 v[204:207], v12 offset:4096
    ds_read_b128 v[208:211], v12 offset:8192
    ds_read_b128 v[212:215], v12 offset:12288
    s_waitcnt lgkmcnt(8)
    v_mfma_f32_32x32x16_bf16 v[64:79], v[216:219], v[224:227], v[64:79]
    v_mfma_f32_32x32x16_bf16 v[80:95], v[216:219], v[228:231], v[80:95]
    v_mfma_f32_32x32x16_bf16 v[96:111], v[216:219], v[232:235], v[96:111]
    v_mfma_f32_32x32x16_bf16 v[112:127], v[216:219], v[236:239], v[112:127]
    v_mfma_f32_32x32x16_bf16 v[128:143], v[220:223], v[224:227], v[128:143]
    v_mfma_f32_32x32x16_bf16 v[144:159], v[220:223], v[228:231], v[144:159]
    v_mfma_f32_32x32x16_bf16 v[160:175], v[220:223], v[232:235], v[160:175]
    v_mfma_f32_32x32x16_bf16 v[176:191], v[220:223], v[236:239], v[176:191]
    ds_read_b64_tr_b16 v[216:217], v18 offset:24576
    ds_read_b64_tr_b16 v[218:219], v18 offset:26624
    ds_read_b64_tr_b16 v[220:221], v19 offset:24576
    ds_read_b64_tr_b16 v[222:223], v19 offset:26624
    ds_read_b128 v[224:227], v13 offset:0
    ds_read_b128 v[228:231], v13 offset:4096
    ds_read_b128 v[232:235], v13 offset:8192
    ds_read_b128 v[236:239], v13 offset:12288
    s_waitcnt lgkmcnt(8)
    v_mfma_f32_32x32x16_bf16 v[64:79], v[192:195], v[200:203], v[64:79]
    v_mfma_f32_32x32x16_bf16 v[80:95], v[192:195], v[204:207], v[80:95]
    v_mfma_f32_32x32x16_bf16 v[96:111], v[192:195], v[208:211], v[96:111]
    v_mfma_f32_32x32x16_bf16 v[112:127], v[192:195], v[212:215], v[112:127]
    v_mfma_f32_32x32x16_bf16 v[128:143], v[196:199], v[200:203], v[128:143]
    v_mfma_f32_32x32x16_bf16 v[144:159], v[196:199], v[204:207], v[144:159]
    v_mfma_f32_32x32x16_bf16 v[160:175], v[196:199], v[208:211], v[160:175]
    v_mfma_f32_32x32x16_bf16 v[176:191], v[196:199], v[212:215], v[176:191]
    s_waitcnt lgkmcnt(0)
    v_mfma_f32_32x32x16_bf16 v[64:79], v[216:219], v[224:227], v[64:79]
    v_mfma_f32_32x32x16_bf16 v[80:95], v[216:219], v[228:231], v[80:95]
    v_mfma_f32_32x32x16_bf16 v[96:111], v[216:219], v[232:235], v[96:111]
    v_mfma_f32_32x32x16_bf16 v[112:127], v[216:219], v[236:239], v[112:127]
    v_mfma_f32_32x32x16_bf16 v[128:143], v[220:223], v[224:227], v[128:143]
    v_mfma_f32_32x32x16_bf16 v[144:159], v[220:223], v[228:231], v[144:159]
    v_mfma_f32_32x32x16_bf16 v[160:175], v[220:223], v[232:235], v[160:175]
    v_mfma_f32_32x32x16_bf16 v[176:191], v[220:223], v[236:239], v[176:191]
    s_cmp_ge_u32 s22, s42
    s_cbranch_scc1 pj_epi
    s_waitcnt vmcnt(0)
    s_barrier
    s_add_u32 s22, s22, 1
    s_cmp_ge_u32 s22, s42
    s_cbranch_scc1 pj_nodma1
    s_add_u32 m0, s25, 0
    s_nop 0
    buffer_load_dwordx4 v24, s[8:11], s20 offen lds
    s_add_u32 m0, s25, 1024
    s_nop 0
    buffer_load_dwordx4 v25, s[8:11], s20 offen lds
    s_add_u32 m0, s25, 2048
    s_nop 0
    buffer_load_dwordx4 v26, s[8:11], s20 offen lds
    s_add_u32 m0, s25, 3072
    s_nop 0
    buffer_load_dwordx4 v27, s[8:11], s20 offen lds
    s_add_u32 m0, s25, 32768
    s_nop 0
    buffer_load_dwordx4 v28, s[12:15], s21 offen lds
    s_add_u32 m0, s25, 33792
    s_nop 0
    buffer_load_dwordx4 v29, s[12:15], s21 offen lds
    s_add_u32 m0, s25, 34816
    s_nop 0
    buffer_load_dwordx4 v30, s[12:15], s21 offen lds
    s_add_u32 m0, s25, 35840
    s_nop 0
    buffer_load_dwordx4 v31, s[12:15], s21 offen lds
    s_add_u32 s20, s20, 128
    s_add_u32 s21, s21, s52
pj_nodma1:
    ds_read_b64_tr_b16 v[192:193], v20 offset:0
    ds_read_b64_tr_b16 v[194:195], v20 offset:2048
    ds_read_b64_tr_b16 v[196:197], v21 offset:0
    ds_read_b64_tr_b16 v[198:199], v21 offset:2048
    ds_read_b128 v[200:203], v14 offset:0
    ds_read_b128 v[204:207], v14 offset:4096
    ds_read_b128 v[208:211], v14 offset:8192
    ds_read_b128 v[212:215], v14 offset:12288
    ds_read_b64_tr_b16 v[216:217], v20 offset:8192
    ds_read_b64_tr_b16 v[218:219], v20 offset:10240
    ds_read_b64_tr_b16 v[220:221], v21 offset:8192
    ds_read_b64_tr_b16 v[222:223], v21 offset:10240
    ds_read_b128 v[224:227], v15 offset:0
    ds_read_b128 v[228:231], v15 offset:4096
    ds_read_b128 v[232:235], v15 offset:8192
    ds_read_b128 v[236:239], v15 offset:12288
    s_waitcnt lgkmcnt(8)
    v_mfma_f32_32x32x16_bf16 v[64:79], v[192:195], v[200:203], v[64:79]
    v_mfma_f32_32x32x16_bf16 v[80:95], v[192:195], v[204:207], v[80:95]
    v_mfma_f32_32x32x16_bf16 v[96:111], v[192:195], v[208:211], v[96:111]
    v_mfma_f32_32x32x16_bf16 v[112:127], v[192:195], v[212:215], v[112:127]
    v_mfma_f32_32x32x16_bf16 v[128:143], v[196:199], v[200:203], v[128:143]
    v_mfma_f32_32x32x16_bf16 v[144:159], v[196:199], v[204:207], v[144:159]
    v_mfma_f32_32x32x16_bf16 v[160:175], v[196:199], v[208:211], v[160:175]
    v_mfma_f32_32x32x16_bf16 v[176:191], v[196:199], v[212:215], v[176:191]
    ds_read_b64_tr_b16 v[192:193], v20 offset:16384
    ds_read_b64_tr_b16 v[194:195], v20 offset:18432
    ds_read_b64_tr_b16 v[196:197], v21 offset:16384
    ds_read_b64_tr_b16 v[198:199], v21 offset:18432
    ds_read_b128 v[200:203], v16 offset:0
    ds_read_b128 v[204:207], v16 offset:4096
    ds_read_b128 v[208:211], v16 offset:8192
    ds_read_b128 v[212:215], v16 offset:12288
    s_waitcnt lgkmcnt(8)
    v_mfma_f32_32x32x16_bf16 v[64:79], v[216:219], v[224:227], v[64:79]
    v_mfma_f32_32x32x16_bf16 v[80:95], v[216:219], v[228:231], v[80:95]
    v_mfma_f32_32x32x16_bf16 v[96:111], v[216:219], v[232:235], v[96:111]
    v_mfma_f32_32x32x16_bf16 v[112:127], v[216:219], v[236:239], v[112:127]
    v_mfma_f32_32x32x16_bf16 v[128:143], v[220:223], v[224:227], v[128:143]
    v_mfma_f32_32x32x16_bf16 v[144:159], v[220:223], v[228:231], v[144:159]
    v_mfma_f32_32x32x16_bf16 v[160:175], v[220:223], v[232:235], v[160:175]
    v_mfma_f32_32x32x16_bf16 v[176:191], v[220:223], v[236:239], v[176:191]
    ds_read_b64_tr_b16 v[216:217], v20 offset:24576
    ds_read_b64_tr_b16 v[218:219], v20 offset:26624
    ds_read_b64_tr_b16 v[220:221], v21 offset:24576
    ds_read_b64_tr_b16 v[222:223], v21 offset:26624
    ds_read_b128 v[224:227], v17 offset:0
    ds_read_b128 v[228:231], v17 offset:4096
    ds_read_b128 v[232:235], v17 offset:8192
    ds_read_b128 v[236:239], v17 offset:12288
    s_waitcnt lgkmcnt(8)
    v_mfma_f32_32x32x16_bf16 v[64:79], v[192:195], v[200:203], v[64:79]
    v_mfma_f32_32x32x16_bf16 v[80:95], v[192:195], v[204:207], v[80:95]
    v_mfma_f32_32x32x16_bf16 v[96:111], v[192:195], v[208:211], v[96:111]
    v_mfma_f32_32x32x16_bf16 v[112:127], v[192:195], v[212:215], v[112:127]
    v_mfma_f32_32x32x16_bf16 v[128:143], v[196:199], v[200:203], v[128:143]
    v_mfma_f32_32x32x16_bf16 v[144:159], v[196:199], v[204:207], v[144:159]
    v_mfma_f32_32x32x16_bf16 v[160:175], v[196:199], v[208:211], v[160:175]
    v_mfma_f32_32x32x16_bf16 v[176:191], v[196:199], v[212:215], v[176:191]
    s_waitcnt lgkmcnt(0)
    v_mfma_f32_32x32x16_bf16 v[64:79], v[216:219], v[224:227], v[64:79]
    v_mfma_f32_32x32x16_bf16 v[80:95], v[216:219], v[228:231], v[80:95]
    v_mfma_f32_32x32x16_bf16 v[96:111], v[216:219], v[232:235], v[96:111]
    v_mfma_f32_32x32x16_bf16 v[112:127], v[216:219], v[236:239], v[112:127]
    v_mfma_f32_32x32x16_bf16 v[128:143], v[220:223], v[224:227], v[128:143]
    v_mfma_f32_32x32x16_bf16 v[144:159], v[220:223], v[228:231], v[144:159]
    v_mfma_f32_32x32x16_bf16 v[160:175], v[220:223], v[232:235], v[160:175]
    v_mfma_f32_32x32x16_bf16 v[176:191], v[220:223], v[236:239], v[176:191]
    s_cmp_ge_u32 s22, s42
    s_cbranch_scc0 pj_loop
pj_epi:
    v_and_b32 v3, 31, v2
    s_lshl_b32 s49, s51, 7
    s_add_u32 s49, s49, s46
    v_add_u32 v3, s49, v3
    v_mul_lo_u32 v3, v3, s44
    v_lshrrev_b32 v4, 5, v2
    v_lshlrev_b32 v4, 3, v4
    v_add_u32 v3, v3, v4
    s_lshl_b32 s49, s50, 7
    s_lshl_b32 s53, s47, 1
    s_cmp_eq_u32 s3, 3
    s_cselect_b32 s53, s53, 0
    s_add_u32 s49, s49, s53
    v_add_u32 v3, s49, v3
    s_lshl_b32 s54, s44, 5
    s_nop 7
    s_nop 7
    s_cmp_eq_u32 s3, 3
    s_cbranch_scc1 pj_epi_h

    s_mov_b32 s55, 0
    v_cvt_pk_bf16_f32 v4, v64, v65
    v_cvt_pk_bf16_f32 v5, v66, v67
    buffer_store_dwordx2 v[4:5], v3, s[16:19], s55 offen offset:0
    v_cvt_pk_bf16_f32 v6, v68, v69
    v_cvt_pk_bf16_f32 v7, v70, v71
    buffer_store_dwordx2 v[6:7], v3, s[16:19], s55 offen offset:16
    v_cvt_pk_bf16_f32 v4, v72, v73
    v_cvt_pk_bf16_f32 v5, v74, v75
    buffer_store_dwordx2 v[4:5], v3, s[16:19], s55 offen offset:32
    v_cvt_pk_bf16_f32 v6, v76, v77
    v_cvt_pk_bf16_f32 v7, v78, v79
    buffer_store_dwordx2 v[6:7], v3, s[16:19], s55 offen offset:48
    v_cvt_pk_bf16_f32 v4, v128, v129
    v_cvt_pk_bf16_f32 v5, v130, v131
    buffer_store_dwordx2 v[4:5], v3, s[16:19], s55 offen offset:64
    v_cvt_pk_bf16_f32 v6, v132, v133
    v_cvt_pk_bf16_f32 v7, v134, v135
    buffer_store_dwordx2 v[6:7], v3, s[16:19], s55 offen offset:80
    v_cvt_pk_bf16_f32 v4, v136, v137
    v_cvt_pk_bf16_f32 v5, v138, v139
    buffer_store_dwordx2 v[4:5], v3, s[16:19], s55 offen offset:96
    v_cvt_pk_bf16_f32 v6, v140, v141
    v_cvt_pk_bf16_f32 v7, v142, v143
    buffer_store_dwordx2 v[6:7], v3, s[16:19], s55 offen offset:112
    s_add_u32 s55, s55, s54
    v_cvt_pk_bf16_f32 v4, v80, v81
    v_cvt_pk_bf16_f32 v5, v82, v83
    buffer_store_dwordx2 v[4:5], v3, s[16:19], s55 offen offset:0
    v_cvt_pk_bf16_f32 v6, v84, v85
    v_cvt_pk_bf16_f32 v7, v86, v87
    buffer_store_dwordx2 v[6:7], v3, s[16:19], s55 offen offset:16
    v_cvt_pk_bf16_f32 v4, v88, v89
    v_cvt_pk_bf16_f32 v5, v90, v91
    buffer_store_dwordx2 v[4:5], v3, s[16:19], s55 offen offset:32
    v_cvt_pk_bf16_f32 v6, v92, v93
    v_cvt_pk_bf16_f32 v7, v94, v95
    buffer_store_dwordx2 v[6:7], v3, s[16:19], s55 offen offset:48
    v_cvt_pk_bf16_f32 v4, v144, v145
    v_cvt_pk_bf16_f32 v5, v146, v147
    buffer_store_dwordx2 v[4:5], v3, s[16:19], s55 offen offset:64
    v_cvt_pk_bf16_f32 v6, v148, v149
    v_cvt_pk_bf16_f32 v7, v150, v151
    buffer_store_dwordx2 v[6:7], v3, s[16:19], s55 offen offset:80
    v_cvt_pk_bf16_f32 v4, v152, v153
    v_cvt_pk_bf16_f32 v5, v154, v155
    buffer_store_dwordx2 v[4:5], v3, s[16:19], s55 offen offset:96
    v_cvt_pk_bf16_f32 v6, v156, v157
    v_cvt_pk_bf16_f32 v7, v158, v159
    buffer_store_dwordx2 v[6:7], v3, s[16:19], s55 offen offset:112
    s_add_u32 s55, s55, s54
    v_cvt_pk_bf16_f32 v4, v96, v97
    v_cvt_pk_bf16_f32 v5, v98, v99
    buffer_store_dwordx2 v[4:5], v3, s[16:19], s55 offen offset:0
    v_cvt_pk_bf16_f32 v6, v100, v101
    v_cvt_pk_bf16_f32 v7, v102, v103
    buffer_store_dwordx2 v[6:7], v3, s[16:19], s55 offen offset:16
    v_cvt_pk_bf16_f32 v4, v104, v105
    v_cvt_pk_bf16_f32 v5, v106, v107
    buffer_store_dwordx2 v[4:5], v3, s[16:19], s55 offen offset:32
    v_cvt_pk_bf16_f32 v6, v108, v109
    v_cvt_pk_bf16_f32 v7, v110, v111
    buffer_store_dwordx2 v[6:7], v3, s[16:19], s55 offen offset:48
    v_cvt_pk_bf16_f32 v4, v160, v161
    v_cvt_pk_bf16_f32 v5, v162, v163
    buffer_store_dwordx2 v[4:5], v3, s[16:19], s55 offen offset:64
    v_cvt_pk_bf16_f32 v6, v164, v165
    v_cvt_pk_bf16_f32 v7, v166, v167
    buffer_store_dwordx2 v[6:7], v3, s[16:19], s55 offen offset:80
    v_cvt_pk_bf16_f32 v4, v168, v169
    v_cvt_pk_bf16_f32 v5, v170, v171
    buffer_store_dwordx2 v[4:5], v3, s[16:19], s55 offen offset:96
    v_cvt_pk_bf16_f32 v6, v172, v173
    v_cvt_pk_bf16_f32 v7, v174, v175
    buffer_store_dwordx2 v[6:7], v3, s[16:19], s55 offen offset:112
    s_add_u32 s55, s55, s54
    v_cvt_pk_bf16_f32 v4, v112, v113
    v_cvt_pk_bf16_f32 v5, v114, v115
    buffer_store_dwordx2 v[4:5], v3, s[16:19], s55 offen offset:0
    v_cvt_pk_bf16_f32 v6, v116, v117
    v_cvt_pk_bf16_f32 v7, v118, v119
    buffer_store_dwordx2 v[6:7], v3, s[16:19], s55 offen offset:16
    v_cvt_pk_bf16_f32 v4, v120, v121
    v_cvt_pk_bf16_f32 v5, v122, v123
    buffer_store_dwordx2 v[4:5], v3, s[16:19], s55 offen offset:32
    v_cvt_pk_bf16_f32 v6, v124, v125
    v_cvt_pk_bf16_f32 v7, v126, v127
    buffer_store_dwordx2 v[6:7], v3, s[16:19], s55 offen offset:48
    v_cvt_pk_bf16_f32 v4, v176, v177
    v_cvt_pk_bf16_f32 v5, v178, v179
    buffer_store_dwordx2 v[4:5], v3, s[16:19], s55 offen offset:64
    v_cvt_pk_bf16_f32 v6, v180, v181
    v_cvt_pk_bf16_f32 v7, v182, v183
    buffer_store_dwordx2 v[6:7], v3, s[16:19], s55 offen offset:80
    v_cvt_pk_bf16_f32 v4, v184, v185
    v_cvt_pk_bf16_f32 v5, v186, v187
    buffer_store_dwordx2 v[4:5], v3, s[16:19], s55 offen offset:96
    v_cvt_pk_bf16_f32 v6, v188, v189
    v_cvt_pk_bf16_f32 v7, v190, v191
    buffer_store_dwordx2 v[6:7], v3, s[16:19], s55 offen offset:112
    s_branch pj_done
pj_epi_h:
    s_mov_b32 s28, s34
    s_mov_b32 s29, s35
    s_mov_b32 s30, 3584
    s_mov_b32 s31, 0x20000
    v_lshrrev_b32 v4, 5, v2
    v_lshlrev_b32 v4, 3, v4
    v_add_u32 v4, s49, v4

    buffer_load_dwordx2 v[32:33], v4, s[28:31], 0 offen offset:0
    buffer_load_dwordx2 v[34:35], v4, s[28:31], 0 offen offset:16
    buffer_load_dwordx2 v[36:37], v4, s[28:31], 0 offen offset:32
    buffer_load_dwordx2 v[38:39], v4, s[28:31], 0 offen offset:48
    buffer_load_dwordx2 v[40:41], v4, s[28:31], 0 offen offset:64
    buffer_load_dwordx2 v[42:43], v4, s[28:31], 0 offen offset:80
    buffer_load_dwordx2 v[44:45], v4, s[28:31], 0 offen offset:96
    buffer_load_dwordx2 v[46:47], v4, s[28:31], 0 offen offset:112
    s_waitcnt vmcnt(0)
    v_lshlrev_b32 v240, 16, v32
    v_and_b32 v241, 0xffff0000, v32
    v_mov_b32 v192, v240
    v_mov_b32 v193, v241
    v_lshlrev_b32 v240, 16, v33
    v_and_b32 v241, 0xffff0000, v33
    v_mov_b32 v194, v240
    v_mov_b32 v195, v241
    v_lshlrev_b32 v240, 16, v34
    v_and_b32 v241, 0xffff0000, v34
    v_mov_b32 v196, v240
    v_mov_b32 v197, v241
    v_lshlrev_b32 v240, 16, v35
    v_and_b32 v241, 0xffff0000, v35
    v_mov_b32 v198, v240
    v_mov_b32 v199, v241
    v_lshlrev_b32 v240, 16, v36
    v_and_b32 v241, 0xffff0000, v36
    v_mov_b32 v200, v240
    v_mov_b32 v201, v241
    v_lshlrev_b32 v240, 16, v37
    v_and_b32 v241, 0xffff0000, v37
    v_mov_b32 v202, v240
    v_mov_b32 v203, v241
    v_lshlrev_b32 v240, 16, v38
    v_and_b32 v241, 0xffff0000, v38
    v_mov_b32 v204, v240
    v_mov_b32 v205, v241
    v_lshlrev_b32 v240, 16, v39
    v_and_b32 v241, 0xffff0000, v39
    v_mov_b32 v206, v240
    v_mov_b32 v207, v241
    v_lshlrev_b32 v240, 16, v40
    v_and_b32 v241, 0xffff0000, v40
    v_mov_b32 v208, v240
    v_mov_b32 v209, v241
    v_lshlrev_b32 v240, 16, v41
    v_and_b32 v241, 0xffff0000, v41
    v_mov_b32 v210, v240
    v_mov_b32 v211, v241
    v_lshlrev_b32 v240, 16, v42
    v_and_b32 v241, 0xffff0000, v42
    v_mov_b32 v212, v240
    v_mov_b32 v213, v241
    v_lshlrev_b32 v240, 16, v43
    v_and_b32 v241, 0xffff0000, v43
    v_mov_b32 v214, v240
    v_mov_b32 v215, v241
    v_lshlrev_b32 v240, 16, v44
    v_and_b32 v241, 0xffff0000, v44
    v_mov_b32 v216, v240
    v_mov_b32 v217, v241
    v_lshlrev_b32 v240, 16, v45
    v_and_b32 v241, 0xffff0000, v45
    v_mov_b32 v218, v240
    v_mov_b32 v219, v241
    v_lshlrev_b32 v240, 16, v46
    v_and_b32 v241, 0xffff0000, v46
    v_mov_b32 v220, v240
    v_mov_b32 v221, v241
    v_lshlrev_b32 v240, 16, v47
    v_and_b32 v241, 0xffff0000, v47
    v_mov_b32 v222, v240
    v_mov_b32 v223, v241
    s_mov_b32 s55, 0
    v_cvt_pk_bf16_f32 v240, v64, v64
    v_lshlrev_b32 v240, 16, v240
    v_add_f32 v240, v240, v192
    v_cvt_pk_bf16_f32 v240, v240, v240
    v_lshlrev_b32 v240, 16, v240
    v_min_f32 v241, 0x41a00000, v240
    v_mul_f32 v241, 0x3fb8aa3b, v241
    v_exp_f32 v241, v241
    s_nop 0
    v_add_f32 v242, 2.0, v241
    v_mul_f32 v242, v242, v241
    v_add_f32 v241, 2.0, v242
    v_rcp_f32 v241, v241
    s_nop 0
    v_mul_f32 v242, v242, v241
    v_mul_f32 v64, v240, v242

    v_cvt_pk_bf16_f32 v240, v65, v65
    v_lshlrev_b32 v240, 16, v240
    v_add_f32 v240, v240, v193
    v_cvt_pk_bf16_f32 v240, v240, v240
    v_lshlrev_b32 v240, 16, v240
    v_min_f32 v241, 0x41a00000, v240
    v_mul_f32 v241, 0x3fb8aa3b, v241
    v_exp_f32 v241, v241
    s_nop 0
    v_add_f32 v242, 2.0, v241
    v_mul_f32 v242, v242, v241
    v_add_f32 v241, 2.0, v242
    v_rcp_f32 v241, v241
    s_nop 0
    v_mul_f32 v242, v242, v241
    v_mul_f32 v65, v240, v242

    v_cvt_pk_bf16_f32 v240, v66, v66
    v_lshlrev_b32 v240, 16, v240
    v_add_f32 v240, v240, v194
    v_cvt_pk_bf16_f32 v240, v240, v240
    v_lshlrev_b32 v240, 16, v240
    v_min_f32 v241, 0x41a00000, v240
    v_mul_f32 v241, 0x3fb8aa3b, v241
    v_exp_f32 v241, v241
    s_nop 0
    v_add_f32 v242, 2.0, v241
    v_mul_f32 v242, v242, v241
    v_add_f32 v241, 2.0, v242
    v_rcp_f32 v241, v241
    s_nop 0
    v_mul_f32 v242, v242, v241
    v_mul_f32 v66, v240, v242

    v_cvt_pk_bf16_f32 v240, v67, v67
    v_lshlrev_b32 v240, 16, v240
    v_add_f32 v240, v240, v195
    v_cvt_pk_bf16_f32 v240, v240, v240
    v_lshlrev_b32 v240, 16, v240
    v_min_f32 v241, 0x41a00000, v240
    v_mul_f32 v241, 0x3fb8aa3b, v241
    v_exp_f32 v241, v241
    s_nop 0
    v_add_f32 v242, 2.0, v241
    v_mul_f32 v242, v242, v241
    v_add_f32 v241, 2.0, v242
    v_rcp_f32 v241, v241
    s_nop 0
    v_mul_f32 v242, v242, v241
    v_mul_f32 v67, v240, v242

    v_cvt_pk_bf16_f32 v4, v64, v65
    v_cvt_pk_bf16_f32 v5, v66, v67
    buffer_store_dwordx2 v[4:5], v3, s[16:19], s55 offen offset:0
    v_cvt_pk_bf16_f32 v240, v68, v68
    v_lshlrev_b32 v240, 16, v240
    v_add_f32 v240, v240, v196
    v_cvt_pk_bf16_f32 v240, v240, v240
    v_lshlrev_b32 v240, 16, v240
    v_min_f32 v241, 0x41a00000, v240
    v_mul_f32 v241, 0x3fb8aa3b, v241
    v_exp_f32 v241, v241
    s_nop 0
    v_add_f32 v242, 2.0, v241
    v_mul_f32 v242, v242, v241
    v_add_f32 v241, 2.0, v242
    v_rcp_f32 v241, v241
    s_nop 0
    v_mul_f32 v242, v242, v241
    v_mul_f32 v68, v240, v242

    v_cvt_pk_bf16_f32 v240, v69, v69
    v_lshlrev_b32 v240, 16, v240
    v_add_f32 v240, v240, v197
    v_cvt_pk_bf16_f32 v240, v240, v240
    v_lshlrev_b32 v240, 16, v240
    v_min_f32 v241, 0x41a00000, v240
    v_mul_f32 v241, 0x3fb8aa3b, v241
    v_exp_f32 v241, v241
    s_nop 0
    v_add_f32 v242, 2.0, v241
    v_mul_f32 v242, v242, v241
    v_add_f32 v241, 2.0, v242
    v_rcp_f32 v241, v241
    s_nop 0
    v_mul_f32 v242, v242, v241
    v_mul_f32 v69, v240, v242

    v_cvt_pk_bf16_f32 v240, v70, v70
    v_lshlrev_b32 v240, 16, v240
    v_add_f32 v240, v240, v198
    v_cvt_pk_bf16_f32 v240, v240, v240
    v_lshlrev_b32 v240, 16, v240
    v_min_f32 v241, 0x41a00000, v240
    v_mul_f32 v241, 0x3fb8aa3b, v241
    v_exp_f32 v241, v241
    s_nop 0
    v_add_f32 v242, 2.0, v241
    v_mul_f32 v242, v242, v241
    v_add_f32 v241, 2.0, v242
    v_rcp_f32 v241, v241
    s_nop 0
    v_mul_f32 v242, v242, v241
    v_mul_f32 v70, v240, v242

    v_cvt_pk_bf16_f32 v240, v71, v71
    v_lshlrev_b32 v240, 16, v240
    v_add_f32 v240, v240, v199
    v_cvt_pk_bf16_f32 v240, v240, v240
    v_lshlrev_b32 v240, 16, v240
    v_min_f32 v241, 0x41a00000, v240
    v_mul_f32 v241, 0x3fb8aa3b, v241
    v_exp_f32 v241, v241
    s_nop 0
    v_add_f32 v242, 2.0, v241
    v_mul_f32 v242, v242, v241
    v_add_f32 v241, 2.0, v242
    v_rcp_f32 v241, v241
    s_nop 0
    v_mul_f32 v242, v242, v241
    v_mul_f32 v71, v240, v242

    v_cvt_pk_bf16_f32 v6, v68, v69
    v_cvt_pk_bf16_f32 v7, v70, v71
    buffer_store_dwordx2 v[6:7], v3, s[16:19], s55 offen offset:16
    v_cvt_pk_bf16_f32 v240, v72, v72
    v_lshlrev_b32 v240, 16, v240
    v_add_f32 v240, v240, v200
    v_cvt_pk_bf16_f32 v240, v240, v240
    v_lshlrev_b32 v240, 16, v240
    v_min_f32 v241, 0x41a00000, v240
    v_mul_f32 v241, 0x3fb8aa3b, v241
    v_exp_f32 v241, v241
    s_nop 0
    v_add_f32 v242, 2.0, v241
    v_mul_f32 v242, v242, v241
    v_add_f32 v241, 2.0, v242
    v_rcp_f32 v241, v241
    s_nop 0
    v_mul_f32 v242, v242, v241
    v_mul_f32 v72, v240, v242

    v_cvt_pk_bf16_f32 v240, v73, v73
    v_lshlrev_b32 v240, 16, v240
    v_add_f32 v240, v240, v201
    v_cvt_pk_bf16_f32 v240, v240, v240
    v_lshlrev_b32 v240, 16, v240
    v_min_f32 v241, 0x41a00000, v240
    v_mul_f32 v241, 0x3fb8aa3b, v241
    v_exp_f32 v241, v241
    s_nop 0
    v_add_f32 v242, 2.0, v241
    v_mul_f32 v242, v242, v241
    v_add_f32 v241, 2.0, v242
    v_rcp_f32 v241, v241
    s_nop 0
    v_mul_f32 v242, v242, v241
    v_mul_f32 v73, v240, v242

    v_cvt_pk_bf16_f32 v240, v74, v74
    v_lshlrev_b32 v240, 16, v240
    v_add_f32 v240, v240, v202
    v_cvt_pk_bf16_f32 v240, v240, v240
    v_lshlrev_b32 v240, 16, v240
    v_min_f32 v241, 0x41a00000, v240
    v_mul_f32 v241, 0x3fb8aa3b, v241
    v_exp_f32 v241, v241
    s_nop 0
    v_add_f32 v242, 2.0, v241
    v_mul_f32 v242, v242, v241
    v_add_f32 v241, 2.0, v242
    v_rcp_f32 v241, v241
    s_nop 0
    v_mul_f32 v242, v242, v241
    v_mul_f32 v74, v240, v242

    v_cvt_pk_bf16_f32 v240, v75, v75
    v_lshlrev_b32 v240, 16, v240
    v_add_f32 v240, v240, v203
    v_cvt_pk_bf16_f32 v240, v240, v240
    v_lshlrev_b32 v240, 16, v240
    v_min_f32 v241, 0x41a00000, v240
    v_mul_f32 v241, 0x3fb8aa3b, v241
    v_exp_f32 v241, v241
    s_nop 0
    v_add_f32 v242, 2.0, v241
    v_mul_f32 v242, v242, v241
    v_add_f32 v241, 2.0, v242
    v_rcp_f32 v241, v241
    s_nop 0
    v_mul_f32 v242, v242, v241
    v_mul_f32 v75, v240, v242

    v_cvt_pk_bf16_f32 v4, v72, v73
    v_cvt_pk_bf16_f32 v5, v74, v75
    buffer_store_dwordx2 v[4:5], v3, s[16:19], s55 offen offset:32
    v_cvt_pk_bf16_f32 v240, v76, v76
    v_lshlrev_b32 v240, 16, v240
    v_add_f32 v240, v240, v204
    v_cvt_pk_bf16_f32 v240, v240, v240
    v_lshlrev_b32 v240, 16, v240
    v_min_f32 v241, 0x41a00000, v240
    v_mul_f32 v241, 0x3fb8aa3b, v241
    v_exp_f32 v241, v241
    s_nop 0
    v_add_f32 v242, 2.0, v241
    v_mul_f32 v242, v242, v241
    v_add_f32 v241, 2.0, v242
    v_rcp_f32 v241, v241
    s_nop 0
    v_mul_f32 v242, v242, v241
    v_mul_f32 v76, v240, v242

    v_cvt_pk_bf16_f32 v240, v77, v77
    v_lshlrev_b32 v240, 16, v240
    v_add_f32 v240, v240, v205
    v_cvt_pk_bf16_f32 v240, v240, v240
    v_lshlrev_b32 v240, 16, v240
    v_min_f32 v241, 0x41a00000, v240
    v_mul_f32 v241, 0x3fb8aa3b, v241
    v_exp_f32 v241, v241
    s_nop 0
    v_add_f32 v242, 2.0, v241
    v_mul_f32 v242, v242, v241
    v_add_f32 v241, 2.0, v242
    v_rcp_f32 v241, v241
    s_nop 0
    v_mul_f32 v242, v242, v241
    v_mul_f32 v77, v240, v242

    v_cvt_pk_bf16_f32 v240, v78, v78
    v_lshlrev_b32 v240, 16, v240
    v_add_f32 v240, v240, v206
    v_cvt_pk_bf16_f32 v240, v240, v240
    v_lshlrev_b32 v240, 16, v240
    v_min_f32 v241, 0x41a00000, v240
    v_mul_f32 v241, 0x3fb8aa3b, v241
    v_exp_f32 v241, v241
    s_nop 0
    v_add_f32 v242, 2.0, v241
    v_mul_f32 v242, v242, v241
    v_add_f32 v241, 2.0, v242
    v_rcp_f32 v241, v241
    s_nop 0
    v_mul_f32 v242, v242, v241
    v_mul_f32 v78, v240, v242

    v_cvt_pk_bf16_f32 v240, v79, v79
    v_lshlrev_b32 v240, 16, v240
    v_add_f32 v240, v240, v207
    v_cvt_pk_bf16_f32 v240, v240, v240
    v_lshlrev_b32 v240, 16, v240
    v_min_f32 v241, 0x41a00000, v240
    v_mul_f32 v241, 0x3fb8aa3b, v241
    v_exp_f32 v241, v241
    s_nop 0
    v_add_f32 v242, 2.0, v241
    v_mul_f32 v242, v242, v241
    v_add_f32 v241, 2.0, v242
    v_rcp_f32 v241, v241
    s_nop 0
    v_mul_f32 v242, v242, v241
    v_mul_f32 v79, v240, v242

    v_cvt_pk_bf16_f32 v6, v76, v77
    v_cvt_pk_bf16_f32 v7, v78, v79
    buffer_store_dwordx2 v[6:7], v3, s[16:19], s55 offen offset:48
    v_cvt_pk_bf16_f32 v240, v128, v128
    v_lshlrev_b32 v240, 16, v240
    v_add_f32 v240, v240, v208
    v_cvt_pk_bf16_f32 v240, v240, v240
    v_lshlrev_b32 v240, 16, v240
    v_min_f32 v241, 0x41a00000, v240
    v_mul_f32 v241, 0x3fb8aa3b, v241
    v_exp_f32 v241, v241
    s_nop 0
    v_add_f32 v242, 2.0, v241
    v_mul_f32 v242, v242, v241
    v_add_f32 v241, 2.0, v242
    v_rcp_f32 v241, v241
    s_nop 0
    v_mul_f32 v242, v242, v241
    v_mul_f32 v128, v240, v242

    v_cvt_pk_bf16_f32 v240, v129, v129
    v_lshlrev_b32 v240, 16, v240
    v_add_f32 v240, v240, v209
    v_cvt_pk_bf16_f32 v240, v240, v240
    v_lshlrev_b32 v240, 16, v240
    v_min_f32 v241, 0x41a00000, v240
    v_mul_f32 v241, 0x3fb8aa3b, v241
    v_exp_f32 v241, v241
    s_nop 0
    v_add_f32 v242, 2.0, v241
    v_mul_f32 v242, v242, v241
    v_add_f32 v241, 2.0, v242
    v_rcp_f32 v241, v241
    s_nop 0
    v_mul_f32 v242, v242, v241
    v_mul_f32 v129, v240, v242

    v_cvt_pk_bf16_f32 v240, v130, v130
    v_lshlrev_b32 v240, 16, v240
    v_add_f32 v240, v240, v210
    v_cvt_pk_bf16_f32 v240, v240, v240
    v_lshlrev_b32 v240, 16, v240
    v_min_f32 v241, 0x41a00000, v240
    v_mul_f32 v241, 0x3fb8aa3b, v241
    v_exp_f32 v241, v241
    s_nop 0
    v_add_f32 v242, 2.0, v241
    v_mul_f32 v242, v242, v241
    v_add_f32 v241, 2.0, v242
    v_rcp_f32 v241, v241
    s_nop 0
    v_mul_f32 v242, v242, v241
    v_mul_f32 v130, v240, v242

    v_cvt_pk_bf16_f32 v240, v131, v131
    v_lshlrev_b32 v240, 16, v240
    v_add_f32 v240, v240, v211
    v_cvt_pk_bf16_f32 v240, v240, v240
    v_lshlrev_b32 v240, 16, v240
    v_min_f32 v241, 0x41a00000, v240
    v_mul_f32 v241, 0x3fb8aa3b, v241
    v_exp_f32 v241, v241
    s_nop 0
    v_add_f32 v242, 2.0, v241
    v_mul_f32 v242, v242, v241
    v_add_f32 v241, 2.0, v242
    v_rcp_f32 v241, v241
    s_nop 0
    v_mul_f32 v242, v242, v241
    v_mul_f32 v131, v240, v242

    v_cvt_pk_bf16_f32 v4, v128, v129
    v_cvt_pk_bf16_f32 v5, v130, v131
    buffer_store_dwordx2 v[4:5], v3, s[16:19], s55 offen offset:64
    v_cvt_pk_bf16_f32 v240, v132, v132
    v_lshlrev_b32 v240, 16, v240
    v_add_f32 v240, v240, v212
    v_cvt_pk_bf16_f32 v240, v240, v240
    v_lshlrev_b32 v240, 16, v240
    v_min_f32 v241, 0x41a00000, v240
    v_mul_f32 v241, 0x3fb8aa3b, v241
    v_exp_f32 v241, v241
    s_nop 0
    v_add_f32 v242, 2.0, v241
    v_mul_f32 v242, v242, v241
    v_add_f32 v241, 2.0, v242
    v_rcp_f32 v241, v241
    s_nop 0
    v_mul_f32 v242, v242, v241
    v_mul_f32 v132, v240, v242

    v_cvt_pk_bf16_f32 v240, v133, v133
    v_lshlrev_b32 v240, 16, v240
    v_add_f32 v240, v240, v213
    v_cvt_pk_bf16_f32 v240, v240, v240
    v_lshlrev_b32 v240, 16, v240
    v_min_f32 v241, 0x41a00000, v240
    v_mul_f32 v241, 0x3fb8aa3b, v241
    v_exp_f32 v241, v241
    s_nop 0
    v_add_f32 v242, 2.0, v241
    v_mul_f32 v242, v242, v241
    v_add_f32 v241, 2.0, v242
    v_rcp_f32 v241, v241
    s_nop 0
    v_mul_f32 v242, v242, v241
    v_mul_f32 v133, v240, v242

    v_cvt_pk_bf16_f32 v240, v134, v134
    v_lshlrev_b32 v240, 16, v240
    v_add_f32 v240, v240, v214
    v_cvt_pk_bf16_f32 v240, v240, v240
    v_lshlrev_b32 v240, 16, v240
    v_min_f32 v241, 0x41a00000, v240
    v_mul_f32 v241, 0x3fb8aa3b, v241
    v_exp_f32 v241, v241
    s_nop 0
    v_add_f32 v242, 2.0, v241
    v_mul_f32 v242, v242, v241
    v_add_f32 v241, 2.0, v242
    v_rcp_f32 v241, v241
    s_nop 0
    v_mul_f32 v242, v242, v241
    v_mul_f32 v134, v240, v242

    v_cvt_pk_bf16_f32 v240, v135, v135
    v_lshlrev_b32 v240, 16, v240
    v_add_f32 v240, v240, v215
    v_cvt_pk_bf16_f32 v240, v240, v240
    v_lshlrev_b32 v240, 16, v240
    v_min_f32 v241, 0x41a00000, v240
    v_mul_f32 v241, 0x3fb8aa3b, v241
    v_exp_f32 v241, v241
    s_nop 0
    v_add_f32 v242, 2.0, v241
    v_mul_f32 v242, v242, v241
    v_add_f32 v241, 2.0, v242
    v_rcp_f32 v241, v241
    s_nop 0
    v_mul_f32 v242, v242, v241
    v_mul_f32 v135, v240, v242

    v_cvt_pk_bf16_f32 v6, v132, v133
    v_cvt_pk_bf16_f32 v7, v134, v135
    buffer_store_dwordx2 v[6:7], v3, s[16:19], s55 offen offset:80
    v_cvt_pk_bf16_f32 v240, v136, v136
    v_lshlrev_b32 v240, 16, v240
    v_add_f32 v240, v240, v216
    v_cvt_pk_bf16_f32 v240, v240, v240
    v_lshlrev_b32 v240, 16, v240
    v_min_f32 v241, 0x41a00000, v240
    v_mul_f32 v241, 0x3fb8aa3b, v241
    v_exp_f32 v241, v241
    s_nop 0
    v_add_f32 v242, 2.0, v241
    v_mul_f32 v242, v242, v241
    v_add_f32 v241, 2.0, v242
    v_rcp_f32 v241, v241
    s_nop 0
    v_mul_f32 v242, v242, v241
    v_mul_f32 v136, v240, v242

    v_cvt_pk_bf16_f32 v240, v137, v137
    v_lshlrev_b32 v240, 16, v240
    v_add_f32 v240, v240, v217
    v_cvt_pk_bf16_f32 v240, v240, v240
    v_lshlrev_b32 v240, 16, v240
    v_min_f32 v241, 0x41a00000, v240
    v_mul_f32 v241, 0x3fb8aa3b, v241
    v_exp_f32 v241, v241
    s_nop 0
    v_add_f32 v242, 2.0, v241
    v_mul_f32 v242, v242, v241
    v_add_f32 v241, 2.0, v242
    v_rcp_f32 v241, v241
    s_nop 0
    v_mul_f32 v242, v242, v241
    v_mul_f32 v137, v240, v242

    v_cvt_pk_bf16_f32 v240, v138, v138
    v_lshlrev_b32 v240, 16, v240
    v_add_f32 v240, v240, v218
    v_cvt_pk_bf16_f32 v240, v240, v240
    v_lshlrev_b32 v240, 16, v240
    v_min_f32 v241, 0x41a00000, v240
    v_mul_f32 v241, 0x3fb8aa3b, v241
    v_exp_f32 v241, v241
    s_nop 0
    v_add_f32 v242, 2.0, v241
    v_mul_f32 v242, v242, v241
    v_add_f32 v241, 2.0, v242
    v_rcp_f32 v241, v241
    s_nop 0
    v_mul_f32 v242, v242, v241
    v_mul_f32 v138, v240, v242

    v_cvt_pk_bf16_f32 v240, v139, v139
    v_lshlrev_b32 v240, 16, v240
    v_add_f32 v240, v240, v219
    v_cvt_pk_bf16_f32 v240, v240, v240
    v_lshlrev_b32 v240, 16, v240
    v_min_f32 v241, 0x41a00000, v240
    v_mul_f32 v241, 0x3fb8aa3b, v241
    v_exp_f32 v241, v241
    s_nop 0
    v_add_f32 v242, 2.0, v241
    v_mul_f32 v242, v242, v241
    v_add_f32 v241, 2.0, v242
    v_rcp_f32 v241, v241
    s_nop 0
    v_mul_f32 v242, v242, v241
    v_mul_f32 v139, v240, v242

    v_cvt_pk_bf16_f32 v4, v136, v137
    v_cvt_pk_bf16_f32 v5, v138, v139
    buffer_store_dwordx2 v[4:5], v3, s[16:19], s55 offen offset:96
    v_cvt_pk_bf16_f32 v240, v140, v140
    v_lshlrev_b32 v240, 16, v240
    v_add_f32 v240, v240, v220
    v_cvt_pk_bf16_f32 v240, v240, v240
    v_lshlrev_b32 v240, 16, v240
    v_min_f32 v241, 0x41a00000, v240
    v_mul_f32 v241, 0x3fb8aa3b, v241
    v_exp_f32 v241, v241
    s_nop 0
    v_add_f32 v242, 2.0, v241
    v_mul_f32 v242, v242, v241
    v_add_f32 v241, 2.0, v242
    v_rcp_f32 v241, v241
    s_nop 0
    v_mul_f32 v242, v242, v241
    v_mul_f32 v140, v240, v242

    v_cvt_pk_bf16_f32 v240, v141, v141
    v_lshlrev_b32 v240, 16, v240
    v_add_f32 v240, v240, v221
    v_cvt_pk_bf16_f32 v240, v240, v240
    v_lshlrev_b32 v240, 16, v240
    v_min_f32 v241, 0x41a00000, v240
    v_mul_f32 v241, 0x3fb8aa3b, v241
    v_exp_f32 v241, v241
    s_nop 0
    v_add_f32 v242, 2.0, v241
    v_mul_f32 v242, v242, v241
    v_add_f32 v241, 2.0, v242
    v_rcp_f32 v241, v241
    s_nop 0
    v_mul_f32 v242, v242, v241
    v_mul_f32 v141, v240, v242

    v_cvt_pk_bf16_f32 v240, v142, v142
    v_lshlrev_b32 v240, 16, v240
    v_add_f32 v240, v240, v222
    v_cvt_pk_bf16_f32 v240, v240, v240
    v_lshlrev_b32 v240, 16, v240
    v_min_f32 v241, 0x41a00000, v240
    v_mul_f32 v241, 0x3fb8aa3b, v241
    v_exp_f32 v241, v241
    s_nop 0
    v_add_f32 v242, 2.0, v241
    v_mul_f32 v242, v242, v241
    v_add_f32 v241, 2.0, v242
    v_rcp_f32 v241, v241
    s_nop 0
    v_mul_f32 v242, v242, v241
    v_mul_f32 v142, v240, v242

    v_cvt_pk_bf16_f32 v240, v143, v143
    v_lshlrev_b32 v240, 16, v240
    v_add_f32 v240, v240, v223
    v_cvt_pk_bf16_f32 v240, v240, v240
    v_lshlrev_b32 v240, 16, v240
    v_min_f32 v241, 0x41a00000, v240
    v_mul_f32 v241, 0x3fb8aa3b, v241
    v_exp_f32 v241, v241
    s_nop 0
    v_add_f32 v242, 2.0, v241
    v_mul_f32 v242, v242, v241
    v_add_f32 v241, 2.0, v242
    v_rcp_f32 v241, v241
    s_nop 0
    v_mul_f32 v242, v242, v241
    v_mul_f32 v143, v240, v242

    v_cvt_pk_bf16_f32 v6, v140, v141
    v_cvt_pk_bf16_f32 v7, v142, v143
    buffer_store_dwordx2 v[6:7], v3, s[16:19], s55 offen offset:112
    s_add_u32 s55, s55, s54
    v_cvt_pk_bf16_f32 v240, v80, v80
    v_lshlrev_b32 v240, 16, v240
    v_add_f32 v240, v240, v192
    v_cvt_pk_bf16_f32 v240, v240, v240
    v_lshlrev_b32 v240, 16, v240
    v_min_f32 v241, 0x41a00000, v240
    v_mul_f32 v241, 0x3fb8aa3b, v241
    v_exp_f32 v241, v241
    s_nop 0
    v_add_f32 v242, 2.0, v241
    v_mul_f32 v242, v242, v241
    v_add_f32 v241, 2.0, v242
    v_rcp_f32 v241, v241
    s_nop 0
    v_mul_f32 v242, v242, v241
    v_mul_f32 v80, v240, v242

    v_cvt_pk_bf16_f32 v240, v81, v81
    v_lshlrev_b32 v240, 16, v240
    v_add_f32 v240, v240, v193
    v_cvt_pk_bf16_f32 v240, v240, v240
    v_lshlrev_b32 v240, 16, v240
    v_min_f32 v241, 0x41a00000, v240
    v_mul_f32 v241, 0x3fb8aa3b, v241
    v_exp_f32 v241, v241
    s_nop 0
    v_add_f32 v242, 2.0, v241
    v_mul_f32 v242, v242, v241
    v_add_f32 v241, 2.0, v242
    v_rcp_f32 v241, v241
    s_nop 0
    v_mul_f32 v242, v242, v241
    v_mul_f32 v81, v240, v242

    v_cvt_pk_bf16_f32 v240, v82, v82
    v_lshlrev_b32 v240, 16, v240
    v_add_f32 v240, v240, v194
    v_cvt_pk_bf16_f32 v240, v240, v240
    v_lshlrev_b32 v240, 16, v240
    v_min_f32 v241, 0x41a00000, v240
    v_mul_f32 v241, 0x3fb8aa3b, v241
    v_exp_f32 v241, v241
    s_nop 0
    v_add_f32 v242, 2.0, v241
    v_mul_f32 v242, v242, v241
    v_add_f32 v241, 2.0, v242
    v_rcp_f32 v241, v241
    s_nop 0
    v_mul_f32 v242, v242, v241
    v_mul_f32 v82, v240, v242

    v_cvt_pk_bf16_f32 v240, v83, v83
    v_lshlrev_b32 v240, 16, v240
    v_add_f32 v240, v240, v195
    v_cvt_pk_bf16_f32 v240, v240, v240
    v_lshlrev_b32 v240, 16, v240
    v_min_f32 v241, 0x41a00000, v240
    v_mul_f32 v241, 0x3fb8aa3b, v241
    v_exp_f32 v241, v241
    s_nop 0
    v_add_f32 v242, 2.0, v241
    v_mul_f32 v242, v242, v241
    v_add_f32 v241, 2.0, v242
    v_rcp_f32 v241, v241
    s_nop 0
    v_mul_f32 v242, v242, v241
    v_mul_f32 v83, v240, v242

    v_cvt_pk_bf16_f32 v4, v80, v81
    v_cvt_pk_bf16_f32 v5, v82, v83
    buffer_store_dwordx2 v[4:5], v3, s[16:19], s55 offen offset:0
    v_cvt_pk_bf16_f32 v240, v84, v84
    v_lshlrev_b32 v240, 16, v240
    v_add_f32 v240, v240, v196
    v_cvt_pk_bf16_f32 v240, v240, v240
    v_lshlrev_b32 v240, 16, v240
    v_min_f32 v241, 0x41a00000, v240
    v_mul_f32 v241, 0x3fb8aa3b, v241
    v_exp_f32 v241, v241
    s_nop 0
    v_add_f32 v242, 2.0, v241
    v_mul_f32 v242, v242, v241
    v_add_f32 v241, 2.0, v242
    v_rcp_f32 v241, v241
    s_nop 0
    v_mul_f32 v242, v242, v241
    v_mul_f32 v84, v240, v242

    v_cvt_pk_bf16_f32 v240, v85, v85
    v_lshlrev_b32 v240, 16, v240
    v_add_f32 v240, v240, v197
    v_cvt_pk_bf16_f32 v240, v240, v240
    v_lshlrev_b32 v240, 16, v240
    v_min_f32 v241, 0x41a00000, v240
    v_mul_f32 v241, 0x3fb8aa3b, v241
    v_exp_f32 v241, v241
    s_nop 0
    v_add_f32 v242, 2.0, v241
    v_mul_f32 v242, v242, v241
    v_add_f32 v241, 2.0, v242
    v_rcp_f32 v241, v241
    s_nop 0
    v_mul_f32 v242, v242, v241
    v_mul_f32 v85, v240, v242

    v_cvt_pk_bf16_f32 v240, v86, v86
    v_lshlrev_b32 v240, 16, v240
    v_add_f32 v240, v240, v198
    v_cvt_pk_bf16_f32 v240, v240, v240
    v_lshlrev_b32 v240, 16, v240
    v_min_f32 v241, 0x41a00000, v240
    v_mul_f32 v241, 0x3fb8aa3b, v241
    v_exp_f32 v241, v241
    s_nop 0
    v_add_f32 v242, 2.0, v241
    v_mul_f32 v242, v242, v241
    v_add_f32 v241, 2.0, v242
    v_rcp_f32 v241, v241
    s_nop 0
    v_mul_f32 v242, v242, v241
    v_mul_f32 v86, v240, v242

    v_cvt_pk_bf16_f32 v240, v87, v87
    v_lshlrev_b32 v240, 16, v240
    v_add_f32 v240, v240, v199
    v_cvt_pk_bf16_f32 v240, v240, v240
    v_lshlrev_b32 v240, 16, v240
    v_min_f32 v241, 0x41a00000, v240
    v_mul_f32 v241, 0x3fb8aa3b, v241
    v_exp_f32 v241, v241
    s_nop 0
    v_add_f32 v242, 2.0, v241
    v_mul_f32 v242, v242, v241
    v_add_f32 v241, 2.0, v242
    v_rcp_f32 v241, v241
    s_nop 0
    v_mul_f32 v242, v242, v241
    v_mul_f32 v87, v240, v242

    v_cvt_pk_bf16_f32 v6, v84, v85
    v_cvt_pk_bf16_f32 v7, v86, v87
    buffer_store_dwordx2 v[6:7], v3, s[16:19], s55 offen offset:16
    v_cvt_pk_bf16_f32 v240, v88, v88
    v_lshlrev_b32 v240, 16, v240
    v_add_f32 v240, v240, v200
    v_cvt_pk_bf16_f32 v240, v240, v240
    v_lshlrev_b32 v240, 16, v240
    v_min_f32 v241, 0x41a00000, v240
    v_mul_f32 v241, 0x3fb8aa3b, v241
    v_exp_f32 v241, v241
    s_nop 0
    v_add_f32 v242, 2.0, v241
    v_mul_f32 v242, v242, v241
    v_add_f32 v241, 2.0, v242
    v_rcp_f32 v241, v241
    s_nop 0
    v_mul_f32 v242, v242, v241
    v_mul_f32 v88, v240, v242

    v_cvt_pk_bf16_f32 v240, v89, v89
    v_lshlrev_b32 v240, 16, v240
    v_add_f32 v240, v240, v201
    v_cvt_pk_bf16_f32 v240, v240, v240
    v_lshlrev_b32 v240, 16, v240
    v_min_f32 v241, 0x41a00000, v240
    v_mul_f32 v241, 0x3fb8aa3b, v241
    v_exp_f32 v241, v241
    s_nop 0
    v_add_f32 v242, 2.0, v241
    v_mul_f32 v242, v242, v241
    v_add_f32 v241, 2.0, v242
    v_rcp_f32 v241, v241
    s_nop 0
    v_mul_f32 v242, v242, v241
    v_mul_f32 v89, v240, v242

    v_cvt_pk_bf16_f32 v240, v90, v90
    v_lshlrev_b32 v240, 16, v240
    v_add_f32 v240, v240, v202
    v_cvt_pk_bf16_f32 v240, v240, v240
    v_lshlrev_b32 v240, 16, v240
    v_min_f32 v241, 0x41a00000, v240
    v_mul_f32 v241, 0x3fb8aa3b, v241
    v_exp_f32 v241, v241
    s_nop 0
    v_add_f32 v242, 2.0, v241
    v_mul_f32 v242, v242, v241
    v_add_f32 v241, 2.0, v242
    v_rcp_f32 v241, v241
    s_nop 0
    v_mul_f32 v242, v242, v241
    v_mul_f32 v90, v240, v242

    v_cvt_pk_bf16_f32 v240, v91, v91
    v_lshlrev_b32 v240, 16, v240
    v_add_f32 v240, v240, v203
    v_cvt_pk_bf16_f32 v240, v240, v240
    v_lshlrev_b32 v240, 16, v240
    v_min_f32 v241, 0x41a00000, v240
    v_mul_f32 v241, 0x3fb8aa3b, v241
    v_exp_f32 v241, v241
    s_nop 0
    v_add_f32 v242, 2.0, v241
    v_mul_f32 v242, v242, v241
    v_add_f32 v241, 2.0, v242
    v_rcp_f32 v241, v241
    s_nop 0
    v_mul_f32 v242, v242, v241
    v_mul_f32 v91, v240, v242

    v_cvt_pk_bf16_f32 v4, v88, v89
    v_cvt_pk_bf16_f32 v5, v90, v91
    buffer_store_dwordx2 v[4:5], v3, s[16:19], s55 offen offset:32
    v_cvt_pk_bf16_f32 v240, v92, v92
    v_lshlrev_b32 v240, 16, v240
    v_add_f32 v240, v240, v204
    v_cvt_pk_bf16_f32 v240, v240, v240
    v_lshlrev_b32 v240, 16, v240
    v_min_f32 v241, 0x41a00000, v240
    v_mul_f32 v241, 0x3fb8aa3b, v241
    v_exp_f32 v241, v241
    s_nop 0
    v_add_f32 v242, 2.0, v241
    v_mul_f32 v242, v242, v241
    v_add_f32 v241, 2.0, v242
    v_rcp_f32 v241, v241
    s_nop 0
    v_mul_f32 v242, v242, v241
    v_mul_f32 v92, v240, v242

    v_cvt_pk_bf16_f32 v240, v93, v93
    v_lshlrev_b32 v240, 16, v240
    v_add_f32 v240, v240, v205
    v_cvt_pk_bf16_f32 v240, v240, v240
    v_lshlrev_b32 v240, 16, v240
    v_min_f32 v241, 0x41a00000, v240
    v_mul_f32 v241, 0x3fb8aa3b, v241
    v_exp_f32 v241, v241
    s_nop 0
    v_add_f32 v242, 2.0, v241
    v_mul_f32 v242, v242, v241
    v_add_f32 v241, 2.0, v242
    v_rcp_f32 v241, v241
    s_nop 0
    v_mul_f32 v242, v242, v241
    v_mul_f32 v93, v240, v242

    v_cvt_pk_bf16_f32 v240, v94, v94
    v_lshlrev_b32 v240, 16, v240
    v_add_f32 v240, v240, v206
    v_cvt_pk_bf16_f32 v240, v240, v240
    v_lshlrev_b32 v240, 16, v240
    v_min_f32 v241, 0x41a00000, v240
    v_mul_f32 v241, 0x3fb8aa3b, v241
    v_exp_f32 v241, v241
    s_nop 0
    v_add_f32 v242, 2.0, v241
    v_mul_f32 v242, v242, v241
    v_add_f32 v241, 2.0, v242
    v_rcp_f32 v241, v241
    s_nop 0
    v_mul_f32 v242, v242, v241
    v_mul_f32 v94, v240, v242

    v_cvt_pk_bf16_f32 v240, v95, v95
    v_lshlrev_b32 v240, 16, v240
    v_add_f32 v240, v240, v207
    v_cvt_pk_bf16_f32 v240, v240, v240
    v_lshlrev_b32 v240, 16, v240
    v_min_f32 v241, 0x41a00000, v240
    v_mul_f32 v241, 0x3fb8aa3b, v241
    v_exp_f32 v241, v241
    s_nop 0
    v_add_f32 v242, 2.0, v241
    v_mul_f32 v242, v242, v241
    v_add_f32 v241, 2.0, v242
    v_rcp_f32 v241, v241
    s_nop 0
    v_mul_f32 v242, v242, v241
    v_mul_f32 v95, v240, v242

    v_cvt_pk_bf16_f32 v6, v92, v93
    v_cvt_pk_bf16_f32 v7, v94, v95
    buffer_store_dwordx2 v[6:7], v3, s[16:19], s55 offen offset:48
    v_cvt_pk_bf16_f32 v240, v144, v144
    v_lshlrev_b32 v240, 16, v240
    v_add_f32 v240, v240, v208
    v_cvt_pk_bf16_f32 v240, v240, v240
    v_lshlrev_b32 v240, 16, v240
    v_min_f32 v241, 0x41a00000, v240
    v_mul_f32 v241, 0x3fb8aa3b, v241
    v_exp_f32 v241, v241
    s_nop 0
    v_add_f32 v242, 2.0, v241
    v_mul_f32 v242, v242, v241
    v_add_f32 v241, 2.0, v242
    v_rcp_f32 v241, v241
    s_nop 0
    v_mul_f32 v242, v242, v241
    v_mul_f32 v144, v240, v242

    v_cvt_pk_bf16_f32 v240, v145, v145
    v_lshlrev_b32 v240, 16, v240
    v_add_f32 v240, v240, v209
    v_cvt_pk_bf16_f32 v240, v240, v240
    v_lshlrev_b32 v240, 16, v240
    v_min_f32 v241, 0x41a00000, v240
    v_mul_f32 v241, 0x3fb8aa3b, v241
    v_exp_f32 v241, v241
    s_nop 0
    v_add_f32 v242, 2.0, v241
    v_mul_f32 v242, v242, v241
    v_add_f32 v241, 2.0, v242
    v_rcp_f32 v241, v241
    s_nop 0
    v_mul_f32 v242, v242, v241
    v_mul_f32 v145, v240, v242

    v_cvt_pk_bf16_f32 v240, v146, v146
    v_lshlrev_b32 v240, 16, v240
    v_add_f32 v240, v240, v210
    v_cvt_pk_bf16_f32 v240, v240, v240
    v_lshlrev_b32 v240, 16, v240
    v_min_f32 v241, 0x41a00000, v240
    v_mul_f32 v241, 0x3fb8aa3b, v241
    v_exp_f32 v241, v241
    s_nop 0
    v_add_f32 v242, 2.0, v241
    v_mul_f32 v242, v242, v241
    v_add_f32 v241, 2.0, v242
    v_rcp_f32 v241, v241
    s_nop 0
    v_mul_f32 v242, v242, v241
    v_mul_f32 v146, v240, v242

    v_cvt_pk_bf16_f32 v240, v147, v147
    v_lshlrev_b32 v240, 16, v240
    v_add_f32 v240, v240, v211
    v_cvt_pk_bf16_f32 v240, v240, v240
    v_lshlrev_b32 v240, 16, v240
    v_min_f32 v241, 0x41a00000, v240
    v_mul_f32 v241, 0x3fb8aa3b, v241
    v_exp_f32 v241, v241
    s_nop 0
    v_add_f32 v242, 2.0, v241
    v_mul_f32 v242, v242, v241
    v_add_f32 v241, 2.0, v242
    v_rcp_f32 v241, v241
    s_nop 0
    v_mul_f32 v242, v242, v241
    v_mul_f32 v147, v240, v242

    v_cvt_pk_bf16_f32 v4, v144, v145
    v_cvt_pk_bf16_f32 v5, v146, v147
    buffer_store_dwordx2 v[4:5], v3, s[16:19], s55 offen offset:64
    v_cvt_pk_bf16_f32 v240, v148, v148
    v_lshlrev_b32 v240, 16, v240
    v_add_f32 v240, v240, v212
    v_cvt_pk_bf16_f32 v240, v240, v240
    v_lshlrev_b32 v240, 16, v240
    v_min_f32 v241, 0x41a00000, v240
    v_mul_f32 v241, 0x3fb8aa3b, v241
    v_exp_f32 v241, v241
    s_nop 0
    v_add_f32 v242, 2.0, v241
    v_mul_f32 v242, v242, v241
    v_add_f32 v241, 2.0, v242
    v_rcp_f32 v241, v241
    s_nop 0
    v_mul_f32 v242, v242, v241
    v_mul_f32 v148, v240, v242

    v_cvt_pk_bf16_f32 v240, v149, v149
    v_lshlrev_b32 v240, 16, v240
    v_add_f32 v240, v240, v213
    v_cvt_pk_bf16_f32 v240, v240, v240
    v_lshlrev_b32 v240, 16, v240
    v_min_f32 v241, 0x41a00000, v240
    v_mul_f32 v241, 0x3fb8aa3b, v241
    v_exp_f32 v241, v241
    s_nop 0
    v_add_f32 v242, 2.0, v241
    v_mul_f32 v242, v242, v241
    v_add_f32 v241, 2.0, v242
    v_rcp_f32 v241, v241
    s_nop 0
    v_mul_f32 v242, v242, v241
    v_mul_f32 v149, v240, v242

    v_cvt_pk_bf16_f32 v240, v150, v150
    v_lshlrev_b32 v240, 16, v240
    v_add_f32 v240, v240, v214
    v_cvt_pk_bf16_f32 v240, v240, v240
    v_lshlrev_b32 v240, 16, v240
    v_min_f32 v241, 0x41a00000, v240
    v_mul_f32 v241, 0x3fb8aa3b, v241
    v_exp_f32 v241, v241
    s_nop 0
    v_add_f32 v242, 2.0, v241
    v_mul_f32 v242, v242, v241
    v_add_f32 v241, 2.0, v242
    v_rcp_f32 v241, v241
    s_nop 0
    v_mul_f32 v242, v242, v241
    v_mul_f32 v150, v240, v242

    v_cvt_pk_bf16_f32 v240, v151, v151
    v_lshlrev_b32 v240, 16, v240
    v_add_f32 v240, v240, v215
    v_cvt_pk_bf16_f32 v240, v240, v240
    v_lshlrev_b32 v240, 16, v240
    v_min_f32 v241, 0x41a00000, v240
    v_mul_f32 v241, 0x3fb8aa3b, v241
    v_exp_f32 v241, v241
    s_nop 0
    v_add_f32 v242, 2.0, v241
    v_mul_f32 v242, v242, v241
    v_add_f32 v241, 2.0, v242
    v_rcp_f32 v241, v241
    s_nop 0
    v_mul_f32 v242, v242, v241
    v_mul_f32 v151, v240, v242

    v_cvt_pk_bf16_f32 v6, v148, v149
    v_cvt_pk_bf16_f32 v7, v150, v151
    buffer_store_dwordx2 v[6:7], v3, s[16:19], s55 offen offset:80
    v_cvt_pk_bf16_f32 v240, v152, v152
    v_lshlrev_b32 v240, 16, v240
    v_add_f32 v240, v240, v216
    v_cvt_pk_bf16_f32 v240, v240, v240
    v_lshlrev_b32 v240, 16, v240
    v_min_f32 v241, 0x41a00000, v240
    v_mul_f32 v241, 0x3fb8aa3b, v241
    v_exp_f32 v241, v241
    s_nop 0
    v_add_f32 v242, 2.0, v241
    v_mul_f32 v242, v242, v241
    v_add_f32 v241, 2.0, v242
    v_rcp_f32 v241, v241
    s_nop 0
    v_mul_f32 v242, v242, v241
    v_mul_f32 v152, v240, v242

    v_cvt_pk_bf16_f32 v240, v153, v153
    v_lshlrev_b32 v240, 16, v240
    v_add_f32 v240, v240, v217
    v_cvt_pk_bf16_f32 v240, v240, v240
    v_lshlrev_b32 v240, 16, v240
    v_min_f32 v241, 0x41a00000, v240
    v_mul_f32 v241, 0x3fb8aa3b, v241
    v_exp_f32 v241, v241
    s_nop 0
    v_add_f32 v242, 2.0, v241
    v_mul_f32 v242, v242, v241
    v_add_f32 v241, 2.0, v242
    v_rcp_f32 v241, v241
    s_nop 0
    v_mul_f32 v242, v242, v241
    v_mul_f32 v153, v240, v242

    v_cvt_pk_bf16_f32 v240, v154, v154
    v_lshlrev_b32 v240, 16, v240
    v_add_f32 v240, v240, v218
    v_cvt_pk_bf16_f32 v240, v240, v240
    v_lshlrev_b32 v240, 16, v240
    v_min_f32 v241, 0x41a00000, v240
    v_mul_f32 v241, 0x3fb8aa3b, v241
    v_exp_f32 v241, v241
    s_nop 0
    v_add_f32 v242, 2.0, v241
    v_mul_f32 v242, v242, v241
    v_add_f32 v241, 2.0, v242
    v_rcp_f32 v241, v241
    s_nop 0
    v_mul_f32 v242, v242, v241
    v_mul_f32 v154, v240, v242

    v_cvt_pk_bf16_f32 v240, v155, v155
    v_lshlrev_b32 v240, 16, v240
    v_add_f32 v240, v240, v219
    v_cvt_pk_bf16_f32 v240, v240, v240
    v_lshlrev_b32 v240, 16, v240
    v_min_f32 v241, 0x41a00000, v240
    v_mul_f32 v241, 0x3fb8aa3b, v241
    v_exp_f32 v241, v241
    s_nop 0
    v_add_f32 v242, 2.0, v241
    v_mul_f32 v242, v242, v241
    v_add_f32 v241, 2.0, v242
    v_rcp_f32 v241, v241
    s_nop 0
    v_mul_f32 v242, v242, v241
    v_mul_f32 v155, v240, v242

    v_cvt_pk_bf16_f32 v4, v152, v153
    v_cvt_pk_bf16_f32 v5, v154, v155
    buffer_store_dwordx2 v[4:5], v3, s[16:19], s55 offen offset:96
    v_cvt_pk_bf16_f32 v240, v156, v156
    v_lshlrev_b32 v240, 16, v240
    v_add_f32 v240, v240, v220
    v_cvt_pk_bf16_f32 v240, v240, v240
    v_lshlrev_b32 v240, 16, v240
    v_min_f32 v241, 0x41a00000, v240
    v_mul_f32 v241, 0x3fb8aa3b, v241
    v_exp_f32 v241, v241
    s_nop 0
    v_add_f32 v242, 2.0, v241
    v_mul_f32 v242, v242, v241
    v_add_f32 v241, 2.0, v242
    v_rcp_f32 v241, v241
    s_nop 0
    v_mul_f32 v242, v242, v241
    v_mul_f32 v156, v240, v242

    v_cvt_pk_bf16_f32 v240, v157, v157
    v_lshlrev_b32 v240, 16, v240
    v_add_f32 v240, v240, v221
    v_cvt_pk_bf16_f32 v240, v240, v240
    v_lshlrev_b32 v240, 16, v240
    v_min_f32 v241, 0x41a00000, v240
    v_mul_f32 v241, 0x3fb8aa3b, v241
    v_exp_f32 v241, v241
    s_nop 0
    v_add_f32 v242, 2.0, v241
    v_mul_f32 v242, v242, v241
    v_add_f32 v241, 2.0, v242
    v_rcp_f32 v241, v241
    s_nop 0
    v_mul_f32 v242, v242, v241
    v_mul_f32 v157, v240, v242

    v_cvt_pk_bf16_f32 v240, v158, v158
    v_lshlrev_b32 v240, 16, v240
    v_add_f32 v240, v240, v222
    v_cvt_pk_bf16_f32 v240, v240, v240
    v_lshlrev_b32 v240, 16, v240
    v_min_f32 v241, 0x41a00000, v240
    v_mul_f32 v241, 0x3fb8aa3b, v241
    v_exp_f32 v241, v241
    s_nop 0
    v_add_f32 v242, 2.0, v241
    v_mul_f32 v242, v242, v241
    v_add_f32 v241, 2.0, v242
    v_rcp_f32 v241, v241
    s_nop 0
    v_mul_f32 v242, v242, v241
    v_mul_f32 v158, v240, v242

    v_cvt_pk_bf16_f32 v240, v159, v159
    v_lshlrev_b32 v240, 16, v240
    v_add_f32 v240, v240, v223
    v_cvt_pk_bf16_f32 v240, v240, v240
    v_lshlrev_b32 v240, 16, v240
    v_min_f32 v241, 0x41a00000, v240
    v_mul_f32 v241, 0x3fb8aa3b, v241
    v_exp_f32 v241, v241
    s_nop 0
    v_add_f32 v242, 2.0, v241
    v_mul_f32 v242, v242, v241
    v_add_f32 v241, 2.0, v242
    v_rcp_f32 v241, v241
    s_nop 0
    v_mul_f32 v242, v242, v241
    v_mul_f32 v159, v240, v242

    v_cvt_pk_bf16_f32 v6, v156, v157
    v_cvt_pk_bf16_f32 v7, v158, v159
    buffer_store_dwordx2 v[6:7], v3, s[16:19], s55 offen offset:112
    s_add_u32 s55, s55, s54
    v_cvt_pk_bf16_f32 v240, v96, v96
    v_lshlrev_b32 v240, 16, v240
    v_add_f32 v240, v240, v192
    v_cvt_pk_bf16_f32 v240, v240, v240
    v_lshlrev_b32 v240, 16, v240
    v_min_f32 v241, 0x41a00000, v240
    v_mul_f32 v241, 0x3fb8aa3b, v241
    v_exp_f32 v241, v241
    s_nop 0
    v_add_f32 v242, 2.0, v241
    v_mul_f32 v242, v242, v241
    v_add_f32 v241, 2.0, v242
    v_rcp_f32 v241, v241
    s_nop 0
    v_mul_f32 v242, v242, v241
    v_mul_f32 v96, v240, v242

    v_cvt_pk_bf16_f32 v240, v97, v97
    v_lshlrev_b32 v240, 16, v240
    v_add_f32 v240, v240, v193
    v_cvt_pk_bf16_f32 v240, v240, v240
    v_lshlrev_b32 v240, 16, v240
    v_min_f32 v241, 0x41a00000, v240
    v_mul_f32 v241, 0x3fb8aa3b, v241
    v_exp_f32 v241, v241
    s_nop 0
    v_add_f32 v242, 2.0, v241
    v_mul_f32 v242, v242, v241
    v_add_f32 v241, 2.0, v242
    v_rcp_f32 v241, v241
    s_nop 0
    v_mul_f32 v242, v242, v241
    v_mul_f32 v97, v240, v242

    v_cvt_pk_bf16_f32 v240, v98, v98
    v_lshlrev_b32 v240, 16, v240
    v_add_f32 v240, v240, v194
    v_cvt_pk_bf16_f32 v240, v240, v240
    v_lshlrev_b32 v240, 16, v240
    v_min_f32 v241, 0x41a00000, v240
    v_mul_f32 v241, 0x3fb8aa3b, v241
    v_exp_f32 v241, v241
    s_nop 0
    v_add_f32 v242, 2.0, v241
    v_mul_f32 v242, v242, v241
    v_add_f32 v241, 2.0, v242
    v_rcp_f32 v241, v241
    s_nop 0
    v_mul_f32 v242, v242, v241
    v_mul_f32 v98, v240, v242

    v_cvt_pk_bf16_f32 v240, v99, v99
    v_lshlrev_b32 v240, 16, v240
    v_add_f32 v240, v240, v195
    v_cvt_pk_bf16_f32 v240, v240, v240
    v_lshlrev_b32 v240, 16, v240
    v_min_f32 v241, 0x41a00000, v240
    v_mul_f32 v241, 0x3fb8aa3b, v241
    v_exp_f32 v241, v241
    s_nop 0
    v_add_f32 v242, 2.0, v241
    v_mul_f32 v242, v242, v241
    v_add_f32 v241, 2.0, v242
    v_rcp_f32 v241, v241
    s_nop 0
    v_mul_f32 v242, v242, v241
    v_mul_f32 v99, v240, v242

    v_cvt_pk_bf16_f32 v4, v96, v97
    v_cvt_pk_bf16_f32 v5, v98, v99
    buffer_store_dwordx2 v[4:5], v3, s[16:19], s55 offen offset:0
    v_cvt_pk_bf16_f32 v240, v100, v100
    v_lshlrev_b32 v240, 16, v240
    v_add_f32 v240, v240, v196
    v_cvt_pk_bf16_f32 v240, v240, v240
    v_lshlrev_b32 v240, 16, v240
    v_min_f32 v241, 0x41a00000, v240
    v_mul_f32 v241, 0x3fb8aa3b, v241
    v_exp_f32 v241, v241
    s_nop 0
    v_add_f32 v242, 2.0, v241
    v_mul_f32 v242, v242, v241
    v_add_f32 v241, 2.0, v242
    v_rcp_f32 v241, v241
    s_nop 0
    v_mul_f32 v242, v242, v241
    v_mul_f32 v100, v240, v242

    v_cvt_pk_bf16_f32 v240, v101, v101
    v_lshlrev_b32 v240, 16, v240
    v_add_f32 v240, v240, v197
    v_cvt_pk_bf16_f32 v240, v240, v240
    v_lshlrev_b32 v240, 16, v240
    v_min_f32 v241, 0x41a00000, v240
    v_mul_f32 v241, 0x3fb8aa3b, v241
    v_exp_f32 v241, v241
    s_nop 0
    v_add_f32 v242, 2.0, v241
    v_mul_f32 v242, v242, v241
    v_add_f32 v241, 2.0, v242
    v_rcp_f32 v241, v241
    s_nop 0
    v_mul_f32 v242, v242, v241
    v_mul_f32 v101, v240, v242

    v_cvt_pk_bf16_f32 v240, v102, v102
    v_lshlrev_b32 v240, 16, v240
    v_add_f32 v240, v240, v198
    v_cvt_pk_bf16_f32 v240, v240, v240
    v_lshlrev_b32 v240, 16, v240
    v_min_f32 v241, 0x41a00000, v240
    v_mul_f32 v241, 0x3fb8aa3b, v241
    v_exp_f32 v241, v241
    s_nop 0
    v_add_f32 v242, 2.0, v241
    v_mul_f32 v242, v242, v241
    v_add_f32 v241, 2.0, v242
    v_rcp_f32 v241, v241
    s_nop 0
    v_mul_f32 v242, v242, v241
    v_mul_f32 v102, v240, v242

    v_cvt_pk_bf16_f32 v240, v103, v103
    v_lshlrev_b32 v240, 16, v240
    v_add_f32 v240, v240, v199
    v_cvt_pk_bf16_f32 v240, v240, v240
    v_lshlrev_b32 v240, 16, v240
    v_min_f32 v241, 0x41a00000, v240
    v_mul_f32 v241, 0x3fb8aa3b, v241
    v_exp_f32 v241, v241
    s_nop 0
    v_add_f32 v242, 2.0, v241
    v_mul_f32 v242, v242, v241
    v_add_f32 v241, 2.0, v242
    v_rcp_f32 v241, v241
    s_nop 0
    v_mul_f32 v242, v242, v241
    v_mul_f32 v103, v240, v242

    v_cvt_pk_bf16_f32 v6, v100, v101
    v_cvt_pk_bf16_f32 v7, v102, v103
    buffer_store_dwordx2 v[6:7], v3, s[16:19], s55 offen offset:16
    v_cvt_pk_bf16_f32 v240, v104, v104
    v_lshlrev_b32 v240, 16, v240
    v_add_f32 v240, v240, v200
    v_cvt_pk_bf16_f32 v240, v240, v240
    v_lshlrev_b32 v240, 16, v240
    v_min_f32 v241, 0x41a00000, v240
    v_mul_f32 v241, 0x3fb8aa3b, v241
    v_exp_f32 v241, v241
    s_nop 0
    v_add_f32 v242, 2.0, v241
    v_mul_f32 v242, v242, v241
    v_add_f32 v241, 2.0, v242
    v_rcp_f32 v241, v241
    s_nop 0
    v_mul_f32 v242, v242, v241
    v_mul_f32 v104, v240, v242

    v_cvt_pk_bf16_f32 v240, v105, v105
    v_lshlrev_b32 v240, 16, v240
    v_add_f32 v240, v240, v201
    v_cvt_pk_bf16_f32 v240, v240, v240
    v_lshlrev_b32 v240, 16, v240
    v_min_f32 v241, 0x41a00000, v240
    v_mul_f32 v241, 0x3fb8aa3b, v241
    v_exp_f32 v241, v241
    s_nop 0
    v_add_f32 v242, 2.0, v241
    v_mul_f32 v242, v242, v241
    v_add_f32 v241, 2.0, v242
    v_rcp_f32 v241, v241
    s_nop 0
    v_mul_f32 v242, v242, v241
    v_mul_f32 v105, v240, v242

    v_cvt_pk_bf16_f32 v240, v106, v106
    v_lshlrev_b32 v240, 16, v240
    v_add_f32 v240, v240, v202
    v_cvt_pk_bf16_f32 v240, v240, v240
    v_lshlrev_b32 v240, 16, v240
    v_min_f32 v241, 0x41a00000, v240
    v_mul_f32 v241, 0x3fb8aa3b, v241
    v_exp_f32 v241, v241
    s_nop 0
    v_add_f32 v242, 2.0, v241
    v_mul_f32 v242, v242, v241
    v_add_f32 v241, 2.0, v242
    v_rcp_f32 v241, v241
    s_nop 0
    v_mul_f32 v242, v242, v241
    v_mul_f32 v106, v240, v242

    v_cvt_pk_bf16_f32 v240, v107, v107
    v_lshlrev_b32 v240, 16, v240
    v_add_f32 v240, v240, v203
    v_cvt_pk_bf16_f32 v240, v240, v240
    v_lshlrev_b32 v240, 16, v240
    v_min_f32 v241, 0x41a00000, v240
    v_mul_f32 v241, 0x3fb8aa3b, v241
    v_exp_f32 v241, v241
    s_nop 0
    v_add_f32 v242, 2.0, v241
    v_mul_f32 v242, v242, v241
    v_add_f32 v241, 2.0, v242
    v_rcp_f32 v241, v241
    s_nop 0
    v_mul_f32 v242, v242, v241
    v_mul_f32 v107, v240, v242

    v_cvt_pk_bf16_f32 v4, v104, v105
    v_cvt_pk_bf16_f32 v5, v106, v107
    buffer_store_dwordx2 v[4:5], v3, s[16:19], s55 offen offset:32
    v_cvt_pk_bf16_f32 v240, v108, v108
    v_lshlrev_b32 v240, 16, v240
    v_add_f32 v240, v240, v204
    v_cvt_pk_bf16_f32 v240, v240, v240
    v_lshlrev_b32 v240, 16, v240
    v_min_f32 v241, 0x41a00000, v240
    v_mul_f32 v241, 0x3fb8aa3b, v241
    v_exp_f32 v241, v241
    s_nop 0
    v_add_f32 v242, 2.0, v241
    v_mul_f32 v242, v242, v241
    v_add_f32 v241, 2.0, v242
    v_rcp_f32 v241, v241
    s_nop 0
    v_mul_f32 v242, v242, v241
    v_mul_f32 v108, v240, v242

    v_cvt_pk_bf16_f32 v240, v109, v109
    v_lshlrev_b32 v240, 16, v240
    v_add_f32 v240, v240, v205
    v_cvt_pk_bf16_f32 v240, v240, v240
    v_lshlrev_b32 v240, 16, v240
    v_min_f32 v241, 0x41a00000, v240
    v_mul_f32 v241, 0x3fb8aa3b, v241
    v_exp_f32 v241, v241
    s_nop 0
    v_add_f32 v242, 2.0, v241
    v_mul_f32 v242, v242, v241
    v_add_f32 v241, 2.0, v242
    v_rcp_f32 v241, v241
    s_nop 0
    v_mul_f32 v242, v242, v241
    v_mul_f32 v109, v240, v242

    v_cvt_pk_bf16_f32 v240, v110, v110
    v_lshlrev_b32 v240, 16, v240
    v_add_f32 v240, v240, v206
    v_cvt_pk_bf16_f32 v240, v240, v240
    v_lshlrev_b32 v240, 16, v240
    v_min_f32 v241, 0x41a00000, v240
    v_mul_f32 v241, 0x3fb8aa3b, v241
    v_exp_f32 v241, v241
    s_nop 0
    v_add_f32 v242, 2.0, v241
    v_mul_f32 v242, v242, v241
    v_add_f32 v241, 2.0, v242
    v_rcp_f32 v241, v241
    s_nop 0
    v_mul_f32 v242, v242, v241
    v_mul_f32 v110, v240, v242

    v_cvt_pk_bf16_f32 v240, v111, v111
    v_lshlrev_b32 v240, 16, v240
    v_add_f32 v240, v240, v207
    v_cvt_pk_bf16_f32 v240, v240, v240
    v_lshlrev_b32 v240, 16, v240
    v_min_f32 v241, 0x41a00000, v240
    v_mul_f32 v241, 0x3fb8aa3b, v241
    v_exp_f32 v241, v241
    s_nop 0
    v_add_f32 v242, 2.0, v241
    v_mul_f32 v242, v242, v241
    v_add_f32 v241, 2.0, v242
    v_rcp_f32 v241, v241
    s_nop 0
    v_mul_f32 v242, v242, v241
    v_mul_f32 v111, v240, v242

    v_cvt_pk_bf16_f32 v6, v108, v109
    v_cvt_pk_bf16_f32 v7, v110, v111
    buffer_store_dwordx2 v[6:7], v3, s[16:19], s55 offen offset:48
    v_cvt_pk_bf16_f32 v240, v160, v160
    v_lshlrev_b32 v240, 16, v240
    v_add_f32 v240, v240, v208
    v_cvt_pk_bf16_f32 v240, v240, v240
    v_lshlrev_b32 v240, 16, v240
    v_min_f32 v241, 0x41a00000, v240
    v_mul_f32 v241, 0x3fb8aa3b, v241
    v_exp_f32 v241, v241
    s_nop 0
    v_add_f32 v242, 2.0, v241
    v_mul_f32 v242, v242, v241
    v_add_f32 v241, 2.0, v242
    v_rcp_f32 v241, v241
    s_nop 0
    v_mul_f32 v242, v242, v241
    v_mul_f32 v160, v240, v242

    v_cvt_pk_bf16_f32 v240, v161, v161
    v_lshlrev_b32 v240, 16, v240
    v_add_f32 v240, v240, v209
    v_cvt_pk_bf16_f32 v240, v240, v240
    v_lshlrev_b32 v240, 16, v240
    v_min_f32 v241, 0x41a00000, v240
    v_mul_f32 v241, 0x3fb8aa3b, v241
    v_exp_f32 v241, v241
    s_nop 0
    v_add_f32 v242, 2.0, v241
    v_mul_f32 v242, v242, v241
    v_add_f32 v241, 2.0, v242
    v_rcp_f32 v241, v241
    s_nop 0
    v_mul_f32 v242, v242, v241
    v_mul_f32 v161, v240, v242

    v_cvt_pk_bf16_f32 v240, v162, v162
    v_lshlrev_b32 v240, 16, v240
    v_add_f32 v240, v240, v210
    v_cvt_pk_bf16_f32 v240, v240, v240
    v_lshlrev_b32 v240, 16, v240
    v_min_f32 v241, 0x41a00000, v240
    v_mul_f32 v241, 0x3fb8aa3b, v241
    v_exp_f32 v241, v241
    s_nop 0
    v_add_f32 v242, 2.0, v241
    v_mul_f32 v242, v242, v241
    v_add_f32 v241, 2.0, v242
    v_rcp_f32 v241, v241
    s_nop 0
    v_mul_f32 v242, v242, v241
    v_mul_f32 v162, v240, v242

    v_cvt_pk_bf16_f32 v240, v163, v163
    v_lshlrev_b32 v240, 16, v240
    v_add_f32 v240, v240, v211
    v_cvt_pk_bf16_f32 v240, v240, v240
    v_lshlrev_b32 v240, 16, v240
    v_min_f32 v241, 0x41a00000, v240
    v_mul_f32 v241, 0x3fb8aa3b, v241
    v_exp_f32 v241, v241
    s_nop 0
    v_add_f32 v242, 2.0, v241
    v_mul_f32 v242, v242, v241
    v_add_f32 v241, 2.0, v242
    v_rcp_f32 v241, v241
    s_nop 0
    v_mul_f32 v242, v242, v241
    v_mul_f32 v163, v240, v242

    v_cvt_pk_bf16_f32 v4, v160, v161
    v_cvt_pk_bf16_f32 v5, v162, v163
    buffer_store_dwordx2 v[4:5], v3, s[16:19], s55 offen offset:64
    v_cvt_pk_bf16_f32 v240, v164, v164
    v_lshlrev_b32 v240, 16, v240
    v_add_f32 v240, v240, v212
    v_cvt_pk_bf16_f32 v240, v240, v240
    v_lshlrev_b32 v240, 16, v240
    v_min_f32 v241, 0x41a00000, v240
    v_mul_f32 v241, 0x3fb8aa3b, v241
    v_exp_f32 v241, v241
    s_nop 0
    v_add_f32 v242, 2.0, v241
    v_mul_f32 v242, v242, v241
    v_add_f32 v241, 2.0, v242
    v_rcp_f32 v241, v241
    s_nop 0
    v_mul_f32 v242, v242, v241
    v_mul_f32 v164, v240, v242

    v_cvt_pk_bf16_f32 v240, v165, v165
    v_lshlrev_b32 v240, 16, v240
    v_add_f32 v240, v240, v213
    v_cvt_pk_bf16_f32 v240, v240, v240
    v_lshlrev_b32 v240, 16, v240
    v_min_f32 v241, 0x41a00000, v240
    v_mul_f32 v241, 0x3fb8aa3b, v241
    v_exp_f32 v241, v241
    s_nop 0
    v_add_f32 v242, 2.0, v241
    v_mul_f32 v242, v242, v241
    v_add_f32 v241, 2.0, v242
    v_rcp_f32 v241, v241
    s_nop 0
    v_mul_f32 v242, v242, v241
    v_mul_f32 v165, v240, v242

    v_cvt_pk_bf16_f32 v240, v166, v166
    v_lshlrev_b32 v240, 16, v240
    v_add_f32 v240, v240, v214
    v_cvt_pk_bf16_f32 v240, v240, v240
    v_lshlrev_b32 v240, 16, v240
    v_min_f32 v241, 0x41a00000, v240
    v_mul_f32 v241, 0x3fb8aa3b, v241
    v_exp_f32 v241, v241
    s_nop 0
    v_add_f32 v242, 2.0, v241
    v_mul_f32 v242, v242, v241
    v_add_f32 v241, 2.0, v242
    v_rcp_f32 v241, v241
    s_nop 0
    v_mul_f32 v242, v242, v241
    v_mul_f32 v166, v240, v242

    v_cvt_pk_bf16_f32 v240, v167, v167
    v_lshlrev_b32 v240, 16, v240
    v_add_f32 v240, v240, v215
    v_cvt_pk_bf16_f32 v240, v240, v240
    v_lshlrev_b32 v240, 16, v240
    v_min_f32 v241, 0x41a00000, v240
    v_mul_f32 v241, 0x3fb8aa3b, v241
    v_exp_f32 v241, v241
    s_nop 0
    v_add_f32 v242, 2.0, v241
    v_mul_f32 v242, v242, v241
    v_add_f32 v241, 2.0, v242
    v_rcp_f32 v241, v241
    s_nop 0
    v_mul_f32 v242, v242, v241
    v_mul_f32 v167, v240, v242

    v_cvt_pk_bf16_f32 v6, v164, v165
    v_cvt_pk_bf16_f32 v7, v166, v167
    buffer_store_dwordx2 v[6:7], v3, s[16:19], s55 offen offset:80
    v_cvt_pk_bf16_f32 v240, v168, v168
    v_lshlrev_b32 v240, 16, v240
    v_add_f32 v240, v240, v216
    v_cvt_pk_bf16_f32 v240, v240, v240
    v_lshlrev_b32 v240, 16, v240
    v_min_f32 v241, 0x41a00000, v240
    v_mul_f32 v241, 0x3fb8aa3b, v241
    v_exp_f32 v241, v241
    s_nop 0
    v_add_f32 v242, 2.0, v241
    v_mul_f32 v242, v242, v241
    v_add_f32 v241, 2.0, v242
    v_rcp_f32 v241, v241
    s_nop 0
    v_mul_f32 v242, v242, v241
    v_mul_f32 v168, v240, v242

    v_cvt_pk_bf16_f32 v240, v169, v169
    v_lshlrev_b32 v240, 16, v240
    v_add_f32 v240, v240, v217
    v_cvt_pk_bf16_f32 v240, v240, v240
    v_lshlrev_b32 v240, 16, v240
    v_min_f32 v241, 0x41a00000, v240
    v_mul_f32 v241, 0x3fb8aa3b, v241
    v_exp_f32 v241, v241
    s_nop 0
    v_add_f32 v242, 2.0, v241
    v_mul_f32 v242, v242, v241
    v_add_f32 v241, 2.0, v242
    v_rcp_f32 v241, v241
    s_nop 0
    v_mul_f32 v242, v242, v241
    v_mul_f32 v169, v240, v242

    v_cvt_pk_bf16_f32 v240, v170, v170
    v_lshlrev_b32 v240, 16, v240
    v_add_f32 v240, v240, v218
    v_cvt_pk_bf16_f32 v240, v240, v240
    v_lshlrev_b32 v240, 16, v240
    v_min_f32 v241, 0x41a00000, v240
    v_mul_f32 v241, 0x3fb8aa3b, v241
    v_exp_f32 v241, v241
    s_nop 0
    v_add_f32 v242, 2.0, v241
    v_mul_f32 v242, v242, v241
    v_add_f32 v241, 2.0, v242
    v_rcp_f32 v241, v241
    s_nop 0
    v_mul_f32 v242, v242, v241
    v_mul_f32 v170, v240, v242

    v_cvt_pk_bf16_f32 v240, v171, v171
    v_lshlrev_b32 v240, 16, v240
    v_add_f32 v240, v240, v219
    v_cvt_pk_bf16_f32 v240, v240, v240
    v_lshlrev_b32 v240, 16, v240
    v_min_f32 v241, 0x41a00000, v240
    v_mul_f32 v241, 0x3fb8aa3b, v241
    v_exp_f32 v241, v241
    s_nop 0
    v_add_f32 v242, 2.0, v241
    v_mul_f32 v242, v242, v241
    v_add_f32 v241, 2.0, v242
    v_rcp_f32 v241, v241
    s_nop 0
    v_mul_f32 v242, v242, v241
    v_mul_f32 v171, v240, v242

    v_cvt_pk_bf16_f32 v4, v168, v169
    v_cvt_pk_bf16_f32 v5, v170, v171
    buffer_store_dwordx2 v[4:5], v3, s[16:19], s55 offen offset:96
    v_cvt_pk_bf16_f32 v240, v172, v172
    v_lshlrev_b32 v240, 16, v240
    v_add_f32 v240, v240, v220
    v_cvt_pk_bf16_f32 v240, v240, v240
    v_lshlrev_b32 v240, 16, v240
    v_min_f32 v241, 0x41a00000, v240
    v_mul_f32 v241, 0x3fb8aa3b, v241
    v_exp_f32 v241, v241
    s_nop 0
    v_add_f32 v242, 2.0, v241
    v_mul_f32 v242, v242, v241
    v_add_f32 v241, 2.0, v242
    v_rcp_f32 v241, v241
    s_nop 0
    v_mul_f32 v242, v242, v241
    v_mul_f32 v172, v240, v242

    v_cvt_pk_bf16_f32 v240, v173, v173
    v_lshlrev_b32 v240, 16, v240
    v_add_f32 v240, v240, v221
    v_cvt_pk_bf16_f32 v240, v240, v240
    v_lshlrev_b32 v240, 16, v240
    v_min_f32 v241, 0x41a00000, v240
    v_mul_f32 v241, 0x3fb8aa3b, v241
    v_exp_f32 v241, v241
    s_nop 0
    v_add_f32 v242, 2.0, v241
    v_mul_f32 v242, v242, v241
    v_add_f32 v241, 2.0, v242
    v_rcp_f32 v241, v241
    s_nop 0
    v_mul_f32 v242, v242, v241
    v_mul_f32 v173, v240, v242

    v_cvt_pk_bf16_f32 v240, v174, v174
    v_lshlrev_b32 v240, 16, v240
    v_add_f32 v240, v240, v222
    v_cvt_pk_bf16_f32 v240, v240, v240
    v_lshlrev_b32 v240, 16, v240
    v_min_f32 v241, 0x41a00000, v240
    v_mul_f32 v241, 0x3fb8aa3b, v241
    v_exp_f32 v241, v241
    s_nop 0
    v_add_f32 v242, 2.0, v241
    v_mul_f32 v242, v242, v241
    v_add_f32 v241, 2.0, v242
    v_rcp_f32 v241, v241
    s_nop 0
    v_mul_f32 v242, v242, v241
    v_mul_f32 v174, v240, v242

    v_cvt_pk_bf16_f32 v240, v175, v175
    v_lshlrev_b32 v240, 16, v240
    v_add_f32 v240, v240, v223
    v_cvt_pk_bf16_f32 v240, v240, v240
    v_lshlrev_b32 v240, 16, v240
    v_min_f32 v241, 0x41a00000, v240
    v_mul_f32 v241, 0x3fb8aa3b, v241
    v_exp_f32 v241, v241
    s_nop 0
    v_add_f32 v242, 2.0, v241
    v_mul_f32 v242, v242, v241
    v_add_f32 v241, 2.0, v242
    v_rcp_f32 v241, v241
    s_nop 0
    v_mul_f32 v242, v242, v241
    v_mul_f32 v175, v240, v242

    v_cvt_pk_bf16_f32 v6, v172, v173
    v_cvt_pk_bf16_f32 v7, v174, v175
    buffer_store_dwordx2 v[6:7], v3, s[16:19], s55 offen offset:112
    s_add_u32 s55, s55, s54
    v_cvt_pk_bf16_f32 v240, v112, v112
    v_lshlrev_b32 v240, 16, v240
    v_add_f32 v240, v240, v192
    v_cvt_pk_bf16_f32 v240, v240, v240
    v_lshlrev_b32 v240, 16, v240
    v_min_f32 v241, 0x41a00000, v240
    v_mul_f32 v241, 0x3fb8aa3b, v241
    v_exp_f32 v241, v241
    s_nop 0
    v_add_f32 v242, 2.0, v241
    v_mul_f32 v242, v242, v241
    v_add_f32 v241, 2.0, v242
    v_rcp_f32 v241, v241
    s_nop 0
    v_mul_f32 v242, v242, v241
    v_mul_f32 v112, v240, v242

    v_cvt_pk_bf16_f32 v240, v113, v113
    v_lshlrev_b32 v240, 16, v240
    v_add_f32 v240, v240, v193
    v_cvt_pk_bf16_f32 v240, v240, v240
    v_lshlrev_b32 v240, 16, v240
    v_min_f32 v241, 0x41a00000, v240
    v_mul_f32 v241, 0x3fb8aa3b, v241
    v_exp_f32 v241, v241
    s_nop 0
    v_add_f32 v242, 2.0, v241
    v_mul_f32 v242, v242, v241
    v_add_f32 v241, 2.0, v242
    v_rcp_f32 v241, v241
    s_nop 0
    v_mul_f32 v242, v242, v241
    v_mul_f32 v113, v240, v242

    v_cvt_pk_bf16_f32 v240, v114, v114
    v_lshlrev_b32 v240, 16, v240
    v_add_f32 v240, v240, v194
    v_cvt_pk_bf16_f32 v240, v240, v240
    v_lshlrev_b32 v240, 16, v240
    v_min_f32 v241, 0x41a00000, v240
    v_mul_f32 v241, 0x3fb8aa3b, v241
    v_exp_f32 v241, v241
    s_nop 0
    v_add_f32 v242, 2.0, v241
    v_mul_f32 v242, v242, v241
    v_add_f32 v241, 2.0, v242
    v_rcp_f32 v241, v241
    s_nop 0
    v_mul_f32 v242, v242, v241
    v_mul_f32 v114, v240, v242

    v_cvt_pk_bf16_f32 v240, v115, v115
    v_lshlrev_b32 v240, 16, v240
    v_add_f32 v240, v240, v195
    v_cvt_pk_bf16_f32 v240, v240, v240
    v_lshlrev_b32 v240, 16, v240
    v_min_f32 v241, 0x41a00000, v240
    v_mul_f32 v241, 0x3fb8aa3b, v241
    v_exp_f32 v241, v241
    s_nop 0
    v_add_f32 v242, 2.0, v241
    v_mul_f32 v242, v242, v241
    v_add_f32 v241, 2.0, v242
    v_rcp_f32 v241, v241
    s_nop 0
    v_mul_f32 v242, v242, v241
    v_mul_f32 v115, v240, v242

    v_cvt_pk_bf16_f32 v4, v112, v113
    v_cvt_pk_bf16_f32 v5, v114, v115
    buffer_store_dwordx2 v[4:5], v3, s[16:19], s55 offen offset:0
    v_cvt_pk_bf16_f32 v240, v116, v116
    v_lshlrev_b32 v240, 16, v240
    v_add_f32 v240, v240, v196
    v_cvt_pk_bf16_f32 v240, v240, v240
    v_lshlrev_b32 v240, 16, v240
    v_min_f32 v241, 0x41a00000, v240
    v_mul_f32 v241, 0x3fb8aa3b, v241
    v_exp_f32 v241, v241
    s_nop 0
    v_add_f32 v242, 2.0, v241
    v_mul_f32 v242, v242, v241
    v_add_f32 v241, 2.0, v242
    v_rcp_f32 v241, v241
    s_nop 0
    v_mul_f32 v242, v242, v241
    v_mul_f32 v116, v240, v242

    v_cvt_pk_bf16_f32 v240, v117, v117
    v_lshlrev_b32 v240, 16, v240
    v_add_f32 v240, v240, v197
    v_cvt_pk_bf16_f32 v240, v240, v240
    v_lshlrev_b32 v240, 16, v240
    v_min_f32 v241, 0x41a00000, v240
    v_mul_f32 v241, 0x3fb8aa3b, v241
    v_exp_f32 v241, v241
    s_nop 0
    v_add_f32 v242, 2.0, v241
    v_mul_f32 v242, v242, v241
    v_add_f32 v241, 2.0, v242
    v_rcp_f32 v241, v241
    s_nop 0
    v_mul_f32 v242, v242, v241
    v_mul_f32 v117, v240, v242

    v_cvt_pk_bf16_f32 v240, v118, v118
    v_lshlrev_b32 v240, 16, v240
    v_add_f32 v240, v240, v198
    v_cvt_pk_bf16_f32 v240, v240, v240
    v_lshlrev_b32 v240, 16, v240
    v_min_f32 v241, 0x41a00000, v240
    v_mul_f32 v241, 0x3fb8aa3b, v241
    v_exp_f32 v241, v241
    s_nop 0
    v_add_f32 v242, 2.0, v241
    v_mul_f32 v242, v242, v241
    v_add_f32 v241, 2.0, v242
    v_rcp_f32 v241, v241
    s_nop 0
    v_mul_f32 v242, v242, v241
    v_mul_f32 v118, v240, v242

    v_cvt_pk_bf16_f32 v240, v119, v119
    v_lshlrev_b32 v240, 16, v240
    v_add_f32 v240, v240, v199
    v_cvt_pk_bf16_f32 v240, v240, v240
    v_lshlrev_b32 v240, 16, v240
    v_min_f32 v241, 0x41a00000, v240
    v_mul_f32 v241, 0x3fb8aa3b, v241
    v_exp_f32 v241, v241
    s_nop 0
    v_add_f32 v242, 2.0, v241
    v_mul_f32 v242, v242, v241
    v_add_f32 v241, 2.0, v242
    v_rcp_f32 v241, v241
    s_nop 0
    v_mul_f32 v242, v242, v241
    v_mul_f32 v119, v240, v242

    v_cvt_pk_bf16_f32 v6, v116, v117
    v_cvt_pk_bf16_f32 v7, v118, v119
    buffer_store_dwordx2 v[6:7], v3, s[16:19], s55 offen offset:16
    v_cvt_pk_bf16_f32 v240, v120, v120
    v_lshlrev_b32 v240, 16, v240
    v_add_f32 v240, v240, v200
    v_cvt_pk_bf16_f32 v240, v240, v240
    v_lshlrev_b32 v240, 16, v240
    v_min_f32 v241, 0x41a00000, v240
    v_mul_f32 v241, 0x3fb8aa3b, v241
    v_exp_f32 v241, v241
    s_nop 0
    v_add_f32 v242, 2.0, v241
    v_mul_f32 v242, v242, v241
    v_add_f32 v241, 2.0, v242
    v_rcp_f32 v241, v241
    s_nop 0
    v_mul_f32 v242, v242, v241
    v_mul_f32 v120, v240, v242

    v_cvt_pk_bf16_f32 v240, v121, v121
    v_lshlrev_b32 v240, 16, v240
    v_add_f32 v240, v240, v201
    v_cvt_pk_bf16_f32 v240, v240, v240
    v_lshlrev_b32 v240, 16, v240
    v_min_f32 v241, 0x41a00000, v240
    v_mul_f32 v241, 0x3fb8aa3b, v241
    v_exp_f32 v241, v241
    s_nop 0
    v_add_f32 v242, 2.0, v241
    v_mul_f32 v242, v242, v241
    v_add_f32 v241, 2.0, v242
    v_rcp_f32 v241, v241
    s_nop 0
    v_mul_f32 v242, v242, v241
    v_mul_f32 v121, v240, v242

    v_cvt_pk_bf16_f32 v240, v122, v122
    v_lshlrev_b32 v240, 16, v240
    v_add_f32 v240, v240, v202
    v_cvt_pk_bf16_f32 v240, v240, v240
    v_lshlrev_b32 v240, 16, v240
    v_min_f32 v241, 0x41a00000, v240
    v_mul_f32 v241, 0x3fb8aa3b, v241
    v_exp_f32 v241, v241
    s_nop 0
    v_add_f32 v242, 2.0, v241
    v_mul_f32 v242, v242, v241
    v_add_f32 v241, 2.0, v242
    v_rcp_f32 v241, v241
    s_nop 0
    v_mul_f32 v242, v242, v241
    v_mul_f32 v122, v240, v242

    v_cvt_pk_bf16_f32 v240, v123, v123
    v_lshlrev_b32 v240, 16, v240
    v_add_f32 v240, v240, v203
    v_cvt_pk_bf16_f32 v240, v240, v240
    v_lshlrev_b32 v240, 16, v240
    v_min_f32 v241, 0x41a00000, v240
    v_mul_f32 v241, 0x3fb8aa3b, v241
    v_exp_f32 v241, v241
    s_nop 0
    v_add_f32 v242, 2.0, v241
    v_mul_f32 v242, v242, v241
    v_add_f32 v241, 2.0, v242
    v_rcp_f32 v241, v241
    s_nop 0
    v_mul_f32 v242, v242, v241
    v_mul_f32 v123, v240, v242

    v_cvt_pk_bf16_f32 v4, v120, v121
    v_cvt_pk_bf16_f32 v5, v122, v123
    buffer_store_dwordx2 v[4:5], v3, s[16:19], s55 offen offset:32
    v_cvt_pk_bf16_f32 v240, v124, v124
    v_lshlrev_b32 v240, 16, v240
    v_add_f32 v240, v240, v204
    v_cvt_pk_bf16_f32 v240, v240, v240
    v_lshlrev_b32 v240, 16, v240
    v_min_f32 v241, 0x41a00000, v240
    v_mul_f32 v241, 0x3fb8aa3b, v241
    v_exp_f32 v241, v241
    s_nop 0
    v_add_f32 v242, 2.0, v241
    v_mul_f32 v242, v242, v241
    v_add_f32 v241, 2.0, v242
    v_rcp_f32 v241, v241
    s_nop 0
    v_mul_f32 v242, v242, v241
    v_mul_f32 v124, v240, v242

    v_cvt_pk_bf16_f32 v240, v125, v125
    v_lshlrev_b32 v240, 16, v240
    v_add_f32 v240, v240, v205
    v_cvt_pk_bf16_f32 v240, v240, v240
    v_lshlrev_b32 v240, 16, v240
    v_min_f32 v241, 0x41a00000, v240
    v_mul_f32 v241, 0x3fb8aa3b, v241
    v_exp_f32 v241, v241
    s_nop 0
    v_add_f32 v242, 2.0, v241
    v_mul_f32 v242, v242, v241
    v_add_f32 v241, 2.0, v242
    v_rcp_f32 v241, v241
    s_nop 0
    v_mul_f32 v242, v242, v241
    v_mul_f32 v125, v240, v242

    v_cvt_pk_bf16_f32 v240, v126, v126
    v_lshlrev_b32 v240, 16, v240
    v_add_f32 v240, v240, v206
    v_cvt_pk_bf16_f32 v240, v240, v240
    v_lshlrev_b32 v240, 16, v240
    v_min_f32 v241, 0x41a00000, v240
    v_mul_f32 v241, 0x3fb8aa3b, v241
    v_exp_f32 v241, v241
    s_nop 0
    v_add_f32 v242, 2.0, v241
    v_mul_f32 v242, v242, v241
    v_add_f32 v241, 2.0, v242
    v_rcp_f32 v241, v241
    s_nop 0
    v_mul_f32 v242, v242, v241
    v_mul_f32 v126, v240, v242

    v_cvt_pk_bf16_f32 v240, v127, v127
    v_lshlrev_b32 v240, 16, v240
    v_add_f32 v240, v240, v207
    v_cvt_pk_bf16_f32 v240, v240, v240
    v_lshlrev_b32 v240, 16, v240
    v_min_f32 v241, 0x41a00000, v240
    v_mul_f32 v241, 0x3fb8aa3b, v241
    v_exp_f32 v241, v241
    s_nop 0
    v_add_f32 v242, 2.0, v241
    v_mul_f32 v242, v242, v241
    v_add_f32 v241, 2.0, v242
    v_rcp_f32 v241, v241
    s_nop 0
    v_mul_f32 v242, v242, v241
    v_mul_f32 v127, v240, v242

    v_cvt_pk_bf16_f32 v6, v124, v125
    v_cvt_pk_bf16_f32 v7, v126, v127
    buffer_store_dwordx2 v[6:7], v3, s[16:19], s55 offen offset:48
    v_cvt_pk_bf16_f32 v240, v176, v176
    v_lshlrev_b32 v240, 16, v240
    v_add_f32 v240, v240, v208
    v_cvt_pk_bf16_f32 v240, v240, v240
    v_lshlrev_b32 v240, 16, v240
    v_min_f32 v241, 0x41a00000, v240
    v_mul_f32 v241, 0x3fb8aa3b, v241
    v_exp_f32 v241, v241
    s_nop 0
    v_add_f32 v242, 2.0, v241
    v_mul_f32 v242, v242, v241
    v_add_f32 v241, 2.0, v242
    v_rcp_f32 v241, v241
    s_nop 0
    v_mul_f32 v242, v242, v241
    v_mul_f32 v176, v240, v242

    v_cvt_pk_bf16_f32 v240, v177, v177
    v_lshlrev_b32 v240, 16, v240
    v_add_f32 v240, v240, v209
    v_cvt_pk_bf16_f32 v240, v240, v240
    v_lshlrev_b32 v240, 16, v240
    v_min_f32 v241, 0x41a00000, v240
    v_mul_f32 v241, 0x3fb8aa3b, v241
    v_exp_f32 v241, v241
    s_nop 0
    v_add_f32 v242, 2.0, v241
    v_mul_f32 v242, v242, v241
    v_add_f32 v241, 2.0, v242
    v_rcp_f32 v241, v241
    s_nop 0
    v_mul_f32 v242, v242, v241
    v_mul_f32 v177, v240, v242

    v_cvt_pk_bf16_f32 v240, v178, v178
    v_lshlrev_b32 v240, 16, v240
    v_add_f32 v240, v240, v210
    v_cvt_pk_bf16_f32 v240, v240, v240
    v_lshlrev_b32 v240, 16, v240
    v_min_f32 v241, 0x41a00000, v240
    v_mul_f32 v241, 0x3fb8aa3b, v241
    v_exp_f32 v241, v241
    s_nop 0
    v_add_f32 v242, 2.0, v241
    v_mul_f32 v242, v242, v241
    v_add_f32 v241, 2.0, v242
    v_rcp_f32 v241, v241
    s_nop 0
    v_mul_f32 v242, v242, v241
    v_mul_f32 v178, v240, v242

    v_cvt_pk_bf16_f32 v240, v179, v179
    v_lshlrev_b32 v240, 16, v240
    v_add_f32 v240, v240, v211
    v_cvt_pk_bf16_f32 v240, v240, v240
    v_lshlrev_b32 v240, 16, v240
    v_min_f32 v241, 0x41a00000, v240
    v_mul_f32 v241, 0x3fb8aa3b, v241
    v_exp_f32 v241, v241
    s_nop 0
    v_add_f32 v242, 2.0, v241
    v_mul_f32 v242, v242, v241
    v_add_f32 v241, 2.0, v242
    v_rcp_f32 v241, v241
    s_nop 0
    v_mul_f32 v242, v242, v241
    v_mul_f32 v179, v240, v242

    v_cvt_pk_bf16_f32 v4, v176, v177
    v_cvt_pk_bf16_f32 v5, v178, v179
    buffer_store_dwordx2 v[4:5], v3, s[16:19], s55 offen offset:64
    v_cvt_pk_bf16_f32 v240, v180, v180
    v_lshlrev_b32 v240, 16, v240
    v_add_f32 v240, v240, v212
    v_cvt_pk_bf16_f32 v240, v240, v240
    v_lshlrev_b32 v240, 16, v240
    v_min_f32 v241, 0x41a00000, v240
    v_mul_f32 v241, 0x3fb8aa3b, v241
    v_exp_f32 v241, v241
    s_nop 0
    v_add_f32 v242, 2.0, v241
    v_mul_f32 v242, v242, v241
    v_add_f32 v241, 2.0, v242
    v_rcp_f32 v241, v241
    s_nop 0
    v_mul_f32 v242, v242, v241
    v_mul_f32 v180, v240, v242

    v_cvt_pk_bf16_f32 v240, v181, v181
    v_lshlrev_b32 v240, 16, v240
    v_add_f32 v240, v240, v213
    v_cvt_pk_bf16_f32 v240, v240, v240
    v_lshlrev_b32 v240, 16, v240
    v_min_f32 v241, 0x41a00000, v240
    v_mul_f32 v241, 0x3fb8aa3b, v241
    v_exp_f32 v241, v241
    s_nop 0
    v_add_f32 v242, 2.0, v241
    v_mul_f32 v242, v242, v241
    v_add_f32 v241, 2.0, v242
    v_rcp_f32 v241, v241
    s_nop 0
    v_mul_f32 v242, v242, v241
    v_mul_f32 v181, v240, v242

    v_cvt_pk_bf16_f32 v240, v182, v182
    v_lshlrev_b32 v240, 16, v240
    v_add_f32 v240, v240, v214
    v_cvt_pk_bf16_f32 v240, v240, v240
    v_lshlrev_b32 v240, 16, v240
    v_min_f32 v241, 0x41a00000, v240
    v_mul_f32 v241, 0x3fb8aa3b, v241
    v_exp_f32 v241, v241
    s_nop 0
    v_add_f32 v242, 2.0, v241
    v_mul_f32 v242, v242, v241
    v_add_f32 v241, 2.0, v242
    v_rcp_f32 v241, v241
    s_nop 0
    v_mul_f32 v242, v242, v241
    v_mul_f32 v182, v240, v242

    v_cvt_pk_bf16_f32 v240, v183, v183
    v_lshlrev_b32 v240, 16, v240
    v_add_f32 v240, v240, v215
    v_cvt_pk_bf16_f32 v240, v240, v240
    v_lshlrev_b32 v240, 16, v240
    v_min_f32 v241, 0x41a00000, v240
    v_mul_f32 v241, 0x3fb8aa3b, v241
    v_exp_f32 v241, v241
    s_nop 0
    v_add_f32 v242, 2.0, v241
    v_mul_f32 v242, v242, v241
    v_add_f32 v241, 2.0, v242
    v_rcp_f32 v241, v241
    s_nop 0
    v_mul_f32 v242, v242, v241
    v_mul_f32 v183, v240, v242

    v_cvt_pk_bf16_f32 v6, v180, v181
    v_cvt_pk_bf16_f32 v7, v182, v183
    buffer_store_dwordx2 v[6:7], v3, s[16:19], s55 offen offset:80
    v_cvt_pk_bf16_f32 v240, v184, v184
    v_lshlrev_b32 v240, 16, v240
    v_add_f32 v240, v240, v216
    v_cvt_pk_bf16_f32 v240, v240, v240
    v_lshlrev_b32 v240, 16, v240
    v_min_f32 v241, 0x41a00000, v240
    v_mul_f32 v241, 0x3fb8aa3b, v241
    v_exp_f32 v241, v241
    s_nop 0
    v_add_f32 v242, 2.0, v241
    v_mul_f32 v242, v242, v241
    v_add_f32 v241, 2.0, v242
    v_rcp_f32 v241, v241
    s_nop 0
    v_mul_f32 v242, v242, v241
    v_mul_f32 v184, v240, v242

    v_cvt_pk_bf16_f32 v240, v185, v185
    v_lshlrev_b32 v240, 16, v240
    v_add_f32 v240, v240, v217
    v_cvt_pk_bf16_f32 v240, v240, v240
    v_lshlrev_b32 v240, 16, v240
    v_min_f32 v241, 0x41a00000, v240
    v_mul_f32 v241, 0x3fb8aa3b, v241
    v_exp_f32 v241, v241
    s_nop 0
    v_add_f32 v242, 2.0, v241
    v_mul_f32 v242, v242, v241
    v_add_f32 v241, 2.0, v242
    v_rcp_f32 v241, v241
    s_nop 0
    v_mul_f32 v242, v242, v241
    v_mul_f32 v185, v240, v242

    v_cvt_pk_bf16_f32 v240, v186, v186
    v_lshlrev_b32 v240, 16, v240
    v_add_f32 v240, v240, v218
    v_cvt_pk_bf16_f32 v240, v240, v240
    v_lshlrev_b32 v240, 16, v240
    v_min_f32 v241, 0x41a00000, v240
    v_mul_f32 v241, 0x3fb8aa3b, v241
    v_exp_f32 v241, v241
    s_nop 0
    v_add_f32 v242, 2.0, v241
    v_mul_f32 v242, v242, v241
    v_add_f32 v241, 2.0, v242
    v_rcp_f32 v241, v241
    s_nop 0
    v_mul_f32 v242, v242, v241
    v_mul_f32 v186, v240, v242

    v_cvt_pk_bf16_f32 v240, v187, v187
    v_lshlrev_b32 v240, 16, v240
    v_add_f32 v240, v240, v219
    v_cvt_pk_bf16_f32 v240, v240, v240
    v_lshlrev_b32 v240, 16, v240
    v_min_f32 v241, 0x41a00000, v240
    v_mul_f32 v241, 0x3fb8aa3b, v241
    v_exp_f32 v241, v241
    s_nop 0
    v_add_f32 v242, 2.0, v241
    v_mul_f32 v242, v242, v241
    v_add_f32 v241, 2.0, v242
    v_rcp_f32 v241, v241
    s_nop 0
    v_mul_f32 v242, v242, v241
    v_mul_f32 v187, v240, v242

    v_cvt_pk_bf16_f32 v4, v184, v185
    v_cvt_pk_bf16_f32 v5, v186, v187
    buffer_store_dwordx2 v[4:5], v3, s[16:19], s55 offen offset:96
    v_cvt_pk_bf16_f32 v240, v188, v188
    v_lshlrev_b32 v240, 16, v240
    v_add_f32 v240, v240, v220
    v_cvt_pk_bf16_f32 v240, v240, v240
    v_lshlrev_b32 v240, 16, v240
    v_min_f32 v241, 0x41a00000, v240
    v_mul_f32 v241, 0x3fb8aa3b, v241
    v_exp_f32 v241, v241
    s_nop 0
    v_add_f32 v242, 2.0, v241
    v_mul_f32 v242, v242, v241
    v_add_f32 v241, 2.0, v242
    v_rcp_f32 v241, v241
    s_nop 0
    v_mul_f32 v242, v242, v241
    v_mul_f32 v188, v240, v242

    v_cvt_pk_bf16_f32 v240, v189, v189
    v_lshlrev_b32 v240, 16, v240
    v_add_f32 v240, v240, v221
    v_cvt_pk_bf16_f32 v240, v240, v240
    v_lshlrev_b32 v240, 16, v240
    v_min_f32 v241, 0x41a00000, v240
    v_mul_f32 v241, 0x3fb8aa3b, v241
    v_exp_f32 v241, v241
    s_nop 0
    v_add_f32 v242, 2.0, v241
    v_mul_f32 v242, v242, v241
    v_add_f32 v241, 2.0, v242
    v_rcp_f32 v241, v241
    s_nop 0
    v_mul_f32 v242, v242, v241
    v_mul_f32 v189, v240, v242

    v_cvt_pk_bf16_f32 v240, v190, v190
    v_lshlrev_b32 v240, 16, v240
    v_add_f32 v240, v240, v222
    v_cvt_pk_bf16_f32 v240, v240, v240
    v_lshlrev_b32 v240, 16, v240
    v_min_f32 v241, 0x41a00000, v240
    v_mul_f32 v241, 0x3fb8aa3b, v241
    v_exp_f32 v241, v241
    s_nop 0
    v_add_f32 v242, 2.0, v241
    v_mul_f32 v242, v242, v241
    v_add_f32 v241, 2.0, v242
    v_rcp_f32 v241, v241
    s_nop 0
    v_mul_f32 v242, v242, v241
    v_mul_f32 v190, v240, v242

    v_cvt_pk_bf16_f32 v240, v191, v191
    v_lshlrev_b32 v240, 16, v240
    v_add_f32 v240, v240, v223
    v_cvt_pk_bf16_f32 v240, v240, v240
    v_lshlrev_b32 v240, 16, v240
    v_min_f32 v241, 0x41a00000, v240
    v_mul_f32 v241, 0x3fb8aa3b, v241
    v_exp_f32 v241, v241
    s_nop 0
    v_add_f32 v242, 2.0, v241
    v_mul_f32 v242, v242, v241
    v_add_f32 v241, 2.0, v242
    v_rcp_f32 v241, v241
    s_nop 0
    v_mul_f32 v242, v242, v241
    v_mul_f32 v191, v240, v242

    v_cvt_pk_bf16_f32 v6, v188, v189
    v_cvt_pk_bf16_f32 v7, v190, v191
    buffer_store_dwordx2 v[6:7], v3, s[16:19], s55 offen offset:112
pj_done:
    s_endpgm

.globl attn_kernel
.p2align 8
.type attn_kernel,@function
attn_kernel:

    s_cmp_ge_u32 s2, 256
    s_cbranch_scc1 at_done
    s_load_dwordx2 s[4:5], s[0:1], 96
    v_lshrrev_b32 v216, 6, v0
    v_and_b32 v243, 63, v0
    s_nop 0
    v_readfirstlane_b32 s24, v216
    s_and_b32 s20, s2, 15
    s_lshr_b32 s21, s2, 4
    s_sub_u32 s21, 15, s21
    s_waitcnt lgkmcnt(0)
    s_lshl_b32 s22, s20, 20
    s_add_u32 s23, s22, 2097152
    s_add_u32 s8, s4, s23
    s_addc_u32 s9, s5, 0
    s_mov_b32 s10, 1048576
    s_mov_b32 s11, 0x20000
    s_add_u32 s23, s22, 18874368
    s_add_u32 s12, s4, s23
    s_addc_u32 s13, s5, 0
    s_mov_b32 s14, 1048576
    s_mov_b32 s15, 0x20000
    s_add_u32 s23, s22, 35651584
    s_add_u32 s16, s4, s23
    s_addc_u32 s17, s5, 0
    s_mov_b32 s18, 1048576
    s_mov_b32 s19, 0x20000
    s_add_u32 s28, s4, 60817408
    s_addc_u32 s29, s5, 0
    s_mov_b32 s30, 16777216
    s_mov_b32 s31, 0x20000
    s_lshl_b32 s25, s21, 7
    s_lshl_b32 s26, s24, 5
    s_add_u32 s25, s25, s26
    v_and_b32 v216, 31, v243
    v_add_u32 v244, s25, v216
    v_lshlrev_b32 v217, 9, v244
    v_lshrrev_b32 v218, 5, v243
    v_lshl_add_u32 v217, v218, 4, v217

    buffer_load_dwordx4 a[0:3], v217, s[8:11], 0 offen offset:0
    buffer_load_dwordx4 a[4:7], v217, s[8:11], 0 offen offset:32
    buffer_load_dwordx4 a[8:11], v217, s[8:11], 0 offen offset:64
    buffer_load_dwordx4 a[12:15], v217, s[8:11], 0 offen offset:96
    buffer_load_dwordx4 a[16:19], v217, s[8:11], 0 offen offset:128
    buffer_load_dwordx4 a[20:23], v217, s[8:11], 0 offen offset:160
    buffer_load_dwordx4 a[24:27], v217, s[8:11], 0 offen offset:192
    buffer_load_dwordx4 a[28:31], v217, s[8:11], 0 offen offset:224
    buffer_load_dwordx4 a[32:35], v217, s[8:11], 0 offen offset:256
    buffer_load_dwordx4 a[36:39], v217, s[8:11], 0 offen offset:288
    buffer_load_dwordx4 a[40:43], v217, s[8:11], 0 offen offset:320
    buffer_load_dwordx4 a[44:47], v217, s[8:11], 0 offen offset:352
    buffer_load_dwordx4 a[48:51], v217, s[8:11], 0 offen offset:384
    buffer_load_dwordx4 a[52:55], v217, s[8:11], 0 offen offset:416
    buffer_load_dwordx4 a[56:59], v217, s[8:11], 0 offen offset:448
    buffer_load_dwordx4 a[60:63], v217, s[8:11], 0 offen offset:480
    s_lshl_b32 s26, s24, 3
    s_add_u32 s26, s26, 0
    s_lshl_b32 s26, s26, 1
    v_lshrrev_b32 v218, 5, v243
    v_add_u32 v218, s26, v218
    v_and_b32 v219, 31, v243
    v_and_b32 v220, 15, v218
    v_xor_b32 v220, v220, v219
    v_lshlrev_b32 v221, 9, v218
    v_lshl_add_u32 v200, v220, 4, v221
    v_and_b32 v220, 3, v218
    v_lshlrev_b32 v220, 2, v220
    v_xor_b32 v220, v220, v219
    v_lshl_add_u32 v208, v220, 4, v221

    s_lshl_b32 s26, s24, 3
    s_add_u32 s26, s26, 1
    s_lshl_b32 s26, s26, 1
    v_lshrrev_b32 v218, 5, v243
    v_add_u32 v218, s26, v218
    v_and_b32 v219, 31, v243
    v_and_b32 v220, 15, v218
    v_xor_b32 v220, v220, v219
    v_lshlrev_b32 v221, 9, v218
    v_lshl_add_u32 v201, v220, 4, v221
    v_and_b32 v220, 3, v218
    v_lshlrev_b32 v220, 2, v220
    v_xor_b32 v220, v220, v219
    v_lshl_add_u32 v209, v220, 4, v221

    s_lshl_b32 s26, s24, 3
    s_add_u32 s26, s26, 2
    s_lshl_b32 s26, s26, 1
    v_lshrrev_b32 v218, 5, v243
    v_add_u32 v218, s26, v218
    v_and_b32 v219, 31, v243
    v_and_b32 v220, 15, v218
    v_xor_b32 v220, v220, v219
    v_lshlrev_b32 v221, 9, v218
    v_lshl_add_u32 v202, v220, 4, v221
    v_and_b32 v220, 3, v218
    v_lshlrev_b32 v220, 2, v220
    v_xor_b32 v220, v220, v219
    v_lshl_add_u32 v210, v220, 4, v221

    s_lshl_b32 s26, s24, 3
    s_add_u32 s26, s26, 3
    s_lshl_b32 s26, s26, 1
    v_lshrrev_b32 v218, 5, v243
    v_add_u32 v218, s26, v218
    v_and_b32 v219, 31, v243
    v_and_b32 v220, 15, v218
    v_xor_b32 v220, v220, v219
    v_lshlrev_b32 v221, 9, v218
    v_lshl_add_u32 v203, v220, 4, v221
    v_and_b32 v220, 3, v218
    v_lshlrev_b32 v220, 2, v220
    v_xor_b32 v220, v220, v219
    v_lshl_add_u32 v211, v220, 4, v221

    s_lshl_b32 s26, s24, 3
    s_add_u32 s26, s26, 4
    s_lshl_b32 s26, s26, 1
    v_lshrrev_b32 v218, 5, v243
    v_add_u32 v218, s26, v218
    v_and_b32 v219, 31, v243
    v_and_b32 v220, 15, v218
    v_xor_b32 v220, v220, v219
    v_lshlrev_b32 v221, 9, v218
    v_lshl_add_u32 v204, v220, 4, v221
    v_and_b32 v220, 3, v218
    v_lshlrev_b32 v220, 2, v220
    v_xor_b32 v220, v220, v219
    v_lshl_add_u32 v212, v220, 4, v221

    s_lshl_b32 s26, s24, 3
    s_add_u32 s26, s26, 5
    s_lshl_b32 s26, s26, 1
    v_lshrrev_b32 v218, 5, v243
    v_add_u32 v218, s26, v218
    v_and_b32 v219, 31, v243
    v_and_b32 v220, 15, v218
    v_xor_b32 v220, v220, v219
    v_lshlrev_b32 v221, 9, v218
    v_lshl_add_u32 v205, v220, 4, v221
    v_and_b32 v220, 3, v218
    v_lshlrev_b32 v220, 2, v220
    v_xor_b32 v220, v220, v219
    v_lshl_add_u32 v213, v220, 4, v221

    s_lshl_b32 s26, s24, 3
    s_add_u32 s26, s26, 6
    s_lshl_b32 s26, s26, 1
    v_lshrrev_b32 v218, 5, v243
    v_add_u32 v218, s26, v218
    v_and_b32 v219, 31, v243
    v_and_b32 v220, 15, v218
    v_xor_b32 v220, v220, v219
    v_lshlrev_b32 v221, 9, v218
    v_lshl_add_u32 v206, v220, 4, v221
    v_and_b32 v220, 3, v218
    v_lshlrev_b32 v220, 2, v220
    v_xor_b32 v220, v220, v219
    v_lshl_add_u32 v214, v220, 4, v221

    s_lshl_b32 s26, s24, 3
    s_add_u32 s26, s26, 7
    s_lshl_b32 s26, s26, 1
    v_lshrrev_b32 v218, 5, v243
    v_add_u32 v218, s26, v218
    v_and_b32 v219, 31, v243
    v_and_b32 v220, 15, v218
    v_xor_b32 v220, v220, v219
    v_lshlrev_b32 v221, 9, v218
    v_lshl_add_u32 v207, v220, 4, v221
    v_and_b32 v220, 3, v218
    v_lshlrev_b32 v220, 2, v220
    v_xor_b32 v220, v220, v219
    v_lshl_add_u32 v215, v220, 4, v221

    v_and_b32 v218, 31, v243
    v_and_b32 v219, 15, v243
    v_lshrrev_b32 v220, 5, v243
    v_lshlrev_b32 v218, 9, v218

    v_add_u32 v221, 0, v220
    v_xor_b32 v221, v221, v219
    v_lshl_add_u32 v176, v221, 4, v218
    v_add_u32 v184, 0x10000, v176

    v_add_u32 v221, 2, v220
    v_xor_b32 v221, v221, v219
    v_lshl_add_u32 v177, v221, 4, v218
    v_add_u32 v185, 0x10000, v177

    v_add_u32 v221, 4, v220
    v_xor_b32 v221, v221, v219
    v_lshl_add_u32 v178, v221, 4, v218
    v_add_u32 v186, 0x10000, v178

    v_add_u32 v221, 6, v220
    v_xor_b32 v221, v221, v219
    v_lshl_add_u32 v179, v221, 4, v218
    v_add_u32 v187, 0x10000, v179

    v_add_u32 v221, 8, v220
    v_xor_b32 v221, v221, v219
    v_lshl_add_u32 v180, v221, 4, v218
    v_add_u32 v188, 0x10000, v180

    v_add_u32 v221, 10, v220
    v_xor_b32 v221, v221, v219
    v_lshl_add_u32 v181, v221, 4, v218
    v_add_u32 v189, 0x10000, v181

    v_add_u32 v221, 12, v220
    v_xor_b32 v221, v221, v219
    v_lshl_add_u32 v182, v221, 4, v218
    v_add_u32 v190, 0x10000, v182

    v_add_u32 v221, 14, v220
    v_xor_b32 v221, v221, v219
    v_lshl_add_u32 v183, v221, 4, v218
    v_add_u32 v191, 0x10000, v183

    v_bfe_u32 v218, v243, 2, 2
    v_lshrrev_b32 v219, 5, v243
    v_lshl_add_u32 v219, v219, 2, v218
    v_lshlrev_b32 v219, 9, v219
    v_add_u32 v219, 0x8000, v219
    v_bfe_u32 v220, v243, 4, 1
    v_lshlrev_b32 v220, 1, v220
    v_bfe_u32 v221, v243, 1, 1
    v_add_u32 v220, v220, v221
    v_and_b32 v221, 1, v243
    v_lshlrev_b32 v221, 3, v221
    v_add_u32 v219, v219, v221

    v_xor_b32 v221, 0, v218
    v_lshl_add_u32 v221, v221, 2, v220
    v_lshl_add_u32 v192, v221, 4, v219
    v_add_u32 v196, 0x10000, v192

    v_xor_b32 v221, 1, v218
    v_lshl_add_u32 v221, v221, 2, v220
    v_lshl_add_u32 v193, v221, 4, v219
    v_add_u32 v197, 0x10000, v193

    v_xor_b32 v221, 2, v218
    v_lshl_add_u32 v221, v221, 2, v220
    v_lshl_add_u32 v194, v221, 4, v219
    v_add_u32 v198, 0x10000, v194

    v_xor_b32 v221, 3, v218
    v_lshl_add_u32 v221, v221, 2, v220
    v_lshl_add_u32 v195, v221, 4, v219
    v_add_u32 v199, 0x10000, v195

    v_mov_b32 v0, 0
    v_mov_b32 v1, 0
    v_mov_b32 v2, 0
    v_mov_b32 v3, 0
    v_mov_b32 v4, 0
    v_mov_b32 v5, 0
    v_mov_b32 v6, 0
    v_mov_b32 v7, 0
    v_mov_b32 v8, 0
    v_mov_b32 v9, 0
    v_mov_b32 v10, 0
    v_mov_b32 v11, 0
    v_mov_b32 v12, 0
    v_mov_b32 v13, 0
    v_mov_b32 v14, 0
    v_mov_b32 v15, 0
    v_mov_b32 v16, 0
    v_mov_b32 v17, 0
    v_mov_b32 v18, 0
    v_mov_b32 v19, 0
    v_mov_b32 v20, 0
    v_mov_b32 v21, 0
    v_mov_b32 v22, 0
    v_mov_b32 v23, 0
    v_mov_b32 v24, 0
    v_mov_b32 v25, 0
    v_mov_b32 v26, 0
    v_mov_b32 v27, 0
    v_mov_b32 v28, 0
    v_mov_b32 v29, 0
    v_mov_b32 v30, 0
    v_mov_b32 v31, 0
    v_mov_b32 v32, 0
    v_mov_b32 v33, 0
    v_mov_b32 v34, 0
    v_mov_b32 v35, 0
    v_mov_b32 v36, 0
    v_mov_b32 v37, 0
    v_mov_b32 v38, 0
    v_mov_b32 v39, 0
    v_mov_b32 v40, 0
    v_mov_b32 v41, 0
    v_mov_b32 v42, 0
    v_mov_b32 v43, 0
    v_mov_b32 v44, 0
    v_mov_b32 v45, 0
    v_mov_b32 v46, 0
    v_mov_b32 v47, 0
    v_mov_b32 v48, 0
    v_mov_b32 v49, 0
    v_mov_b32 v50, 0
    v_mov_b32 v51, 0
    v_mov_b32 v52, 0
    v_mov_b32 v53, 0
    v_mov_b32 v54, 0
    v_mov_b32 v55, 0
    v_mov_b32 v56, 0
    v_mov_b32 v57, 0
    v_mov_b32 v58, 0
    v_mov_b32 v59, 0
    v_mov_b32 v60, 0
    v_mov_b32 v61, 0
    v_mov_b32 v62, 0
    v_mov_b32 v63, 0
    v_mov_b32 v64, 0
    v_mov_b32 v65, 0
    v_mov_b32 v66, 0
    v_mov_b32 v67, 0
    v_mov_b32 v68, 0
    v_mov_b32 v69, 0
    v_mov_b32 v70, 0
    v_mov_b32 v71, 0
    v_mov_b32 v72, 0
    v_mov_b32 v73, 0
    v_mov_b32 v74, 0
    v_mov_b32 v75, 0
    v_mov_b32 v76, 0
    v_mov_b32 v77, 0
    v_mov_b32 v78, 0
    v_mov_b32 v79, 0
    v_mov_b32 v80, 0
    v_mov_b32 v81, 0
    v_mov_b32 v82, 0
    v_mov_b32 v83, 0
    v_mov_b32 v84, 0
    v_mov_b32 v85, 0
    v_mov_b32 v86, 0
    v_mov_b32 v87, 0
    v_mov_b32 v88, 0
    v_mov_b32 v89, 0
    v_mov_b32 v90, 0
    v_mov_b32 v91, 0
    v_mov_b32 v92, 0
    v_mov_b32 v93, 0
    v_mov_b32 v94, 0
    v_mov_b32 v95, 0
    v_mov_b32 v96, 0
    v_mov_b32 v97, 0
    v_mov_b32 v98, 0
    v_mov_b32 v99, 0
    v_mov_b32 v100, 0
    v_mov_b32 v101, 0
    v_mov_b32 v102, 0
    v_mov_b32 v103, 0
    v_mov_b32 v104, 0
    v_mov_b32 v105, 0
    v_mov_b32 v106, 0
    v_mov_b32 v107, 0
    v_mov_b32 v108, 0
    v_mov_b32 v109, 0
    v_mov_b32 v110, 0
    v_mov_b32 v111, 0
    v_mov_b32 v112, 0
    v_mov_b32 v113, 0
    v_mov_b32 v114, 0
    v_mov_b32 v115, 0
    v_mov_b32 v116, 0
    v_mov_b32 v117, 0
    v_mov_b32 v118, 0
    v_mov_b32 v119, 0
    v_mov_b32 v120, 0
    v_mov_b32 v121, 0
    v_mov_b32 v122, 0
    v_mov_b32 v123, 0
    v_mov_b32 v124, 0
    v_mov_b32 v125, 0
    v_mov_b32 v126, 0
    v_mov_b32 v127, 0
    v_mov_b32 v240, 0xf149f2ca
    v_mov_b32 v241, 0
    s_lshl_b32 s32, s24, 13
    s_mov_b32 s33, 0
    s_lshl_b32 s34, s21, 1
    s_add_u32 s34, s34, 2
    s_mov_b32 s35, 0

    s_add_u32 m0, s32, 0
    s_nop 0
    buffer_load_dwordx4 v200, s[12:15], s33 offen lds
    s_add_u32 m0, s32, 1024
    s_nop 0
    buffer_load_dwordx4 v201, s[12:15], s33 offen lds
    s_add_u32 m0, s32, 2048
    s_nop 0
    buffer_load_dwordx4 v202, s[12:15], s33 offen lds
    s_add_u32 m0, s32, 3072
    s_nop 0
    buffer_load_dwordx4 v203, s[12:15], s33 offen lds
    s_add_u32 m0, s32, 4096
    s_nop 0
    buffer_load_dwordx4 v204, s[12:15], s33 offen lds
    s_add_u32 m0, s32, 5120
    s_nop 0
    buffer_load_dwordx4 v205, s[12:15], s33 offen lds
    s_add_u32 m0, s32, 6144
    s_nop 0
    buffer_load_dwordx4 v206, s[12:15], s33 offen lds
    s_add_u32 m0, s32, 7168
    s_nop 0
    buffer_load_dwordx4 v207, s[12:15], s33 offen lds
    s_add_u32 m0, s32, 32768
    s_nop 0
    buffer_load_dwordx4 v208, s[16:19], s33 offen lds
    s_add_u32 m0, s32, 33792
    s_nop 0
    buffer_load_dwordx4 v209, s[16:19], s33 offen lds
    s_add_u32 m0, s32, 34816
    s_nop 0
    buffer_load_dwordx4 v210, s[16:19], s33 offen lds
    s_add_u32 m0, s32, 35840
    s_nop 0
    buffer_load_dwordx4 v211, s[16:19], s33 offen lds
    s_add_u32 m0, s32, 36864
    s_nop 0
    buffer_load_dwordx4 v212, s[16:19], s33 offen lds
    s_add_u32 m0, s32, 37888
    s_nop 0
    buffer_load_dwordx4 v213, s[16:19], s33 offen lds
    s_add_u32 m0, s32, 38912
    s_nop 0
    buffer_load_dwordx4 v214, s[16:19], s33 offen lds
    s_add_u32 m0, s32, 39936
    s_nop 0
    buffer_load_dwordx4 v215, s[16:19], s33 offen lds
    s_add_u32 s33, s33, 32768
at_loop:
    s_waitcnt vmcnt(0)
    s_barrier
    s_add_u32 s36, s35, 1
    s_cmp_ge_u32 s36, s34
    s_cbranch_scc1 at_nodma0
    s_add_u32 m0, s32, 65536
    s_nop 0
    buffer_load_dwordx4 v200, s[12:15], s33 offen lds
    s_add_u32 m0, s32, 66560
    s_nop 0
    buffer_load_dwordx4 v201, s[12:15], s33 offen lds
    s_add_u32 m0, s32, 67584
    s_nop 0
    buffer_load_dwordx4 v202, s[12:15], s33 offen lds
    s_add_u32 m0, s32, 68608
    s_nop 0
    buffer_load_dwordx4 v203, s[12:15], s33 offen lds
    s_add_u32 m0, s32, 69632
    s_nop 0
    buffer_load_dwordx4 v204, s[12:15], s33 offen lds
    s_add_u32 m0, s32, 70656
    s_nop 0
    buffer_load_dwordx4 v205, s[12:15], s33 offen lds
    s_add_u32 m0, s32, 71680
    s_nop 0
    buffer_load_dwordx4 v206, s[12:15], s33 offen lds
    s_add_u32 m0, s32, 72704
    s_nop 0
    buffer_load_dwordx4 v207, s[12:15], s33 offen lds
    s_add_u32 m0, s32, 98304
    s_nop 0
    buffer_load_dwordx4 v208, s[16:19], s33 offen lds
    s_add_u32 m0, s32, 99328
    s_nop 0
    buffer_load_dwordx4 v209, s[16:19], s33 offen lds
    s_add_u32 m0, s32, 100352
    s_nop 0
    buffer_load_dwordx4 v210, s[16:19], s33 offen lds
    s_add_u32 m0, s32, 101376
    s_nop 0
    buffer_load_dwordx4 v211, s[16:19], s33 offen lds
    s_add_u32 m0, s32, 102400
    s_nop 0
    buffer_load_dwordx4 v212, s[16:19], s33 offen lds
    s_add_u32 m0, s32, 103424
    s_nop 0
    buffer_load_dwordx4 v213, s[16:19], s33 offen lds
    s_add_u32 m0, s32, 104448
    s_nop 0
    buffer_load_dwordx4 v214, s[16:19], s33 offen lds
    s_add_u32 m0, s32, 105472
    s_nop 0
    buffer_load_dwordx4 v215, s[16:19], s33 offen lds
    s_add_u32 s33, s33, 32768
at_nodma0:
    v_mov_b32 v128, 0
    v_mov_b32 v129, 0
    v_mov_b32 v130, 0
    v_mov_b32 v131, 0
    v_mov_b32 v132, 0
    v_mov_b32 v133, 0
    v_mov_b32 v134, 0
    v_mov_b32 v135, 0
    v_mov_b32 v136, 0
    v_mov_b32 v137, 0
    v_mov_b32 v138, 0
    v_mov_b32 v139, 0
    v_mov_b32 v140, 0
    v_mov_b32 v141, 0
    v_mov_b32 v142, 0
    v_mov_b32 v143, 0
    v_mov_b32 v144, 0
    v_mov_b32 v145, 0
    v_mov_b32 v146, 0
    v_mov_b32 v147, 0
    v_mov_b32 v148, 0
    v_mov_b32 v149, 0
    v_mov_b32 v150, 0
    v_mov_b32 v151, 0
    v_mov_b32 v152, 0
    v_mov_b32 v153, 0
    v_mov_b32 v154, 0
    v_mov_b32 v155, 0
    v_mov_b32 v156, 0
    v_mov_b32 v157, 0
    v_mov_b32 v158, 0
    v_mov_b32 v159, 0
    ds_read_b128 a[64:67], v176 offset:0
    ds_read_b128 a[68:71], v177 offset:0
    ds_read_b128 a[72:75], v178 offset:0
    ds_read_b128 a[76:79], v179 offset:0
    s_waitcnt lgkmcnt(3)
    v_mfma_f32_32x32x16_bf16 v[128:143], a[64:67], a[0:3], v[128:143]
    ds_read_b128 a[64:67], v180 offset:0
    s_waitcnt lgkmcnt(3)
    v_mfma_f32_32x32x16_bf16 v[128:143], a[68:71], a[4:7], v[128:143]
    ds_read_b128 a[68:71], v181 offset:0
    s_waitcnt lgkmcnt(3)
    v_mfma_f32_32x32x16_bf16 v[128:143], a[72:75], a[8:11], v[128:143]
    ds_read_b128 a[72:75], v182 offset:0
    s_waitcnt lgkmcnt(3)
    v_mfma_f32_32x32x16_bf16 v[128:143], a[76:79], a[12:15], v[128:143]
    ds_read_b128 a[76:79], v183 offset:0
    s_waitcnt lgkmcnt(3)
    v_mfma_f32_32x32x16_bf16 v[128:143], a[64:67], a[16:19], v[128:143]
    ds_read_b128 a[64:67], v176 offset:256
    s_waitcnt lgkmcnt(3)
    v_mfma_f32_32x32x16_bf16 v[128:143], a[68:71], a[20:23], v[128:143]
    ds_read_b128 a[68:71], v177 offset:256
    s_waitcnt lgkmcnt(3)
    v_mfma_f32_32x32x16_bf16 v[128:143], a[72:75], a[24:27], v[128:143]
    ds_read_b128 a[72:75], v178 offset:256
    s_waitcnt lgkmcnt(3)
    v_mfma_f32_32x32x16_bf16 v[128:143], a[76:79], a[28:31], v[128:143]
    ds_read_b128 a[76:79], v179 offset:256
    s_waitcnt lgkmcnt(3)
    v_mfma_f32_32x32x16_bf16 v[128:143], a[64:67], a[32:35], v[128:143]
    ds_read_b128 a[64:67], v180 offset:256
    s_waitcnt lgkmcnt(3)
    v_mfma_f32_32x32x16_bf16 v[128:143], a[68:71], a[36:39], v[128:143]
    ds_read_b128 a[68:71], v181 offset:256
    s_waitcnt lgkmcnt(3)
    v_mfma_f32_32x32x16_bf16 v[128:143], a[72:75], a[40:43], v[128:143]
    ds_read_b128 a[72:75], v182 offset:256
    s_waitcnt lgkmcnt(3)
    v_mfma_f32_32x32x16_bf16 v[128:143], a[76:79], a[44:47], v[128:143]
    ds_read_b128 a[76:79], v183 offset:256
    s_waitcnt lgkmcnt(3)
    v_mfma_f32_32x32x16_bf16 v[128:143], a[64:67], a[48:51], v[128:143]
    ds_read_b128 a[64:67], v176 offset:16384
    s_waitcnt lgkmcnt(3)
    v_mfma_f32_32x32x16_bf16 v[128:143], a[68:71], a[52:55], v[128:143]
    ds_read_b128 a[68:71], v177 offset:16384
    s_waitcnt lgkmcnt(3)
    v_mfma_f32_32x32x16_bf16 v[128:143], a[72:75], a[56:59], v[128:143]
    ds_read_b128 a[72:75], v178 offset:16384
    s_waitcnt lgkmcnt(3)
    v_mfma_f32_32x32x16_bf16 v[128:143], a[76:79], a[60:63], v[128:143]
    ds_read_b128 a[76:79], v179 offset:16384
    s_waitcnt lgkmcnt(3)
    v_mfma_f32_32x32x16_bf16 v[144:159], a[64:67], a[0:3], v[144:159]
    ds_read_b128 a[64:67], v180 offset:16384
    s_waitcnt lgkmcnt(3)
    v_mfma_f32_32x32x16_bf16 v[144:159], a[68:71], a[4:7], v[144:159]
    ds_read_b128 a[68:71], v181 offset:16384
    s_waitcnt lgkmcnt(3)
    v_mfma_f32_32x32x16_bf16 v[144:159], a[72:75], a[8:11], v[144:159]
    ds_read_b128 a[72:75], v182 offset:16384
    s_waitcnt lgkmcnt(3)
    v_mfma_f32_32x32x16_bf16 v[144:159], a[76:79], a[12:15], v[144:159]
    ds_read_b128 a[76:79], v183 offset:16384
    s_waitcnt lgkmcnt(3)
    v_mfma_f32_32x32x16_bf16 v[144:159], a[64:67], a[16:19], v[144:159]
    ds_read_b128 a[64:67], v176 offset:16640
    s_waitcnt lgkmcnt(3)
    v_mfma_f32_32x32x16_bf16 v[144:159], a[68:71], a[20:23], v[144:159]
    ds_read_b128 a[68:71], v177 offset:16640
    s_waitcnt lgkmcnt(3)
    v_mfma_f32_32x32x16_bf16 v[144:159], a[72:75], a[24:27], v[144:159]
    ds_read_b128 a[72:75], v178 offset:16640
    s_waitcnt lgkmcnt(3)
    v_mfma_f32_32x32x16_bf16 v[144:159], a[76:79], a[28:31], v[144:159]
    ds_read_b128 a[76:79], v179 offset:16640
    s_waitcnt lgkmcnt(3)
    v_mfma_f32_32x32x16_bf16 v[144:159], a[64:67], a[32:35], v[144:159]
    ds_read_b128 a[64:67], v180 offset:16640
    s_waitcnt lgkmcnt(3)
    v_mfma_f32_32x32x16_bf16 v[144:159], a[68:71], a[36:39], v[144:159]
    ds_read_b128 a[68:71], v181 offset:16640
    s_waitcnt lgkmcnt(3)
    v_mfma_f32_32x32x16_bf16 v[144:159], a[72:75], a[40:43], v[144:159]
    ds_read_b128 a[72:75], v182 offset:16640
    s_waitcnt lgkmcnt(3)
    v_mfma_f32_32x32x16_bf16 v[144:159], a[76:79], a[44:47], v[144:159]
    ds_read_b128 a[76:79], v183 offset:16640
    s_waitcnt lgkmcnt(3)
    v_mfma_f32_32x32x16_bf16 v[144:159], a[64:67], a[48:51], v[144:159]
    s_waitcnt lgkmcnt(2)
    v_mfma_f32_32x32x16_bf16 v[144:159], a[68:71], a[52:55], v[144:159]
    s_waitcnt lgkmcnt(1)
    v_mfma_f32_32x32x16_bf16 v[144:159], a[72:75], a[56:59], v[144:159]
    s_waitcnt lgkmcnt(0)
    v_mfma_f32_32x32x16_bf16 v[144:159], a[76:79], a[60:63], v[144:159]
    ds_read_b64_tr_b16 a[80:81], v192 offset:0
    ds_read_b64_tr_b16 a[82:83], v192 offset:4096
    ds_read_b64_tr_b16 a[84:85], v193 offset:0
    ds_read_b64_tr_b16 a[86:87], v193 offset:4096
    ds_read_b64_tr_b16 a[88:89], v194 offset:0
    ds_read_b64_tr_b16 a[90:91], v194 offset:4096
    s_nop 7
    s_nop 7
    s_add_u32 s36, s35, 2
    s_cmp_lt_u32 s36, s34
    s_cbranch_scc1 at_nomask_1
    s_lshl_b32 s36, s35, 6
    v_lshrrev_b32 v216, 5, v243
    v_lshlrev_b32 v216, 2, v216
    v_add_u32 v216, s36, v216

    v_add_u32 v217, 0, v216
    v_cmp_le_u32 vcc, v217, v244
    v_mov_b32 v218, 0xf149f2ca
    v_cndmask_b32 v128, v218, v128, vcc
    v_add_u32 v217, 1, v216
    v_cmp_le_u32 vcc, v217, v244
    v_mov_b32 v218, 0xf149f2ca
    v_cndmask_b32 v129, v218, v129, vcc
    v_add_u32 v217, 2, v216
    v_cmp_le_u32 vcc, v217, v244
    v_mov_b32 v218, 0xf149f2ca
    v_cndmask_b32 v130, v218, v130, vcc
    v_add_u32 v217, 3, v216
    v_cmp_le_u32 vcc, v217, v244
    v_mov_b32 v218, 0xf149f2ca
    v_cndmask_b32 v131, v218, v131, vcc
    v_add_u32 v217, 8, v216
    v_cmp_le_u32 vcc, v217, v244
    v_mov_b32 v218, 0xf149f2ca
    v_cndmask_b32 v132, v218, v132, vcc
    v_add_u32 v217, 9, v216
    v_cmp_le_u32 vcc, v217, v244
    v_mov_b32 v218, 0xf149f2ca
    v_cndmask_b32 v133, v218, v133, vcc
    v_add_u32 v217, 10, v216
    v_cmp_le_u32 vcc, v217, v244
    v_mov_b32 v218, 0xf149f2ca
    v_cndmask_b32 v134, v218, v134, vcc
    v_add_u32 v217, 11, v216
    v_cmp_le_u32 vcc, v217, v244
    v_mov_b32 v218, 0xf149f2ca
    v_cndmask_b32 v135, v218, v135, vcc
    v_add_u32 v217, 16, v216
    v_cmp_le_u32 vcc, v217, v244
    v_mov_b32 v218, 0xf149f2ca
    v_cndmask_b32 v136, v218, v136, vcc
    v_add_u32 v217, 17, v216
    v_cmp_le_u32 vcc, v217, v244
    v_mov_b32 v218, 0xf149f2ca
    v_cndmask_b32 v137, v218, v137, vcc
    v_add_u32 v217, 18, v216
    v_cmp_le_u32 vcc, v217, v244
    v_mov_b32 v218, 0xf149f2ca
    v_cndmask_b32 v138, v218, v138, vcc
    v_add_u32 v217, 19, v216
    v_cmp_le_u32 vcc, v217, v244
    v_mov_b32 v218, 0xf149f2ca
    v_cndmask_b32 v139, v218, v139, vcc
    v_add_u32 v217, 24, v216
    v_cmp_le_u32 vcc, v217, v244
    v_mov_b32 v218, 0xf149f2ca
    v_cndmask_b32 v140, v218, v140, vcc
    v_add_u32 v217, 25, v216
    v_cmp_le_u32 vcc, v217, v244
    v_mov_b32 v218, 0xf149f2ca
    v_cndmask_b32 v141, v218, v141, vcc
    v_add_u32 v217, 26, v216
    v_cmp_le_u32 vcc, v217, v244
    v_mov_b32 v218, 0xf149f2ca
    v_cndmask_b32 v142, v218, v142, vcc
    v_add_u32 v217, 27, v216
    v_cmp_le_u32 vcc, v217, v244
    v_mov_b32 v218, 0xf149f2ca
    v_cndmask_b32 v143, v218, v143, vcc
    v_add_u32 v217, 32, v216
    v_cmp_le_u32 vcc, v217, v244
    v_mov_b32 v218, 0xf149f2ca
    v_cndmask_b32 v144, v218, v144, vcc
    v_add_u32 v217, 33, v216
    v_cmp_le_u32 vcc, v217, v244
    v_mov_b32 v218, 0xf149f2ca
    v_cndmask_b32 v145, v218, v145, vcc
    v_add_u32 v217, 34, v216
    v_cmp_le_u32 vcc, v217, v244
    v_mov_b32 v218, 0xf149f2ca
    v_cndmask_b32 v146, v218, v146, vcc
    v_add_u32 v217, 35, v216
    v_cmp_le_u32 vcc, v217, v244
    v_mov_b32 v218, 0xf149f2ca
    v_cndmask_b32 v147, v218, v147, vcc
    v_add_u32 v217, 40, v216
    v_cmp_le_u32 vcc, v217, v244
    v_mov_b32 v218, 0xf149f2ca
    v_cndmask_b32 v148, v218, v148, vcc
    v_add_u32 v217, 41, v216
    v_cmp_le_u32 vcc, v217, v244
    v_mov_b32 v218, 0xf149f2ca
    v_cndmask_b32 v149, v218, v149, vcc
    v_add_u32 v217, 42, v216
    v_cmp_le_u32 vcc, v217, v244
    v_mov_b32 v218, 0xf149f2ca
    v_cndmask_b32 v150, v218, v150, vcc
    v_add_u32 v217, 43, v216
    v_cmp_le_u32 vcc, v217, v244
    v_mov_b32 v218, 0xf149f2ca
    v_cndmask_b32 v151, v218, v151, vcc
    v_add_u32 v217, 48, v216
    v_cmp_le_u32 vcc, v217, v244
    v_mov_b32 v218, 0xf149f2ca
    v_cndmask_b32 v152, v218, v152, vcc
    v_add_u32 v217, 49, v216
    v_cmp_le_u32 vcc, v217, v244
    v_mov_b32 v218, 0xf149f2ca
    v_cndmask_b32 v153, v218, v153, vcc
    v_add_u32 v217, 50, v216
    v_cmp_le_u32 vcc, v217, v244
    v_mov_b32 v218, 0xf149f2ca
    v_cndmask_b32 v154, v218, v154, vcc
    v_add_u32 v217, 51, v216
    v_cmp_le_u32 vcc, v217, v244
    v_mov_b32 v218, 0xf149f2ca
    v_cndmask_b32 v155, v218, v155, vcc
    v_add_u32 v217, 56, v216
    v_cmp_le_u32 vcc, v217, v244
    v_mov_b32 v218, 0xf149f2ca
    v_cndmask_b32 v156, v218, v156, vcc
    v_add_u32 v217, 57, v216
    v_cmp_le_u32 vcc, v217, v244
    v_mov_b32 v218, 0xf149f2ca
    v_cndmask_b32 v157, v218, v157, vcc
    v_add_u32 v217, 58, v216
    v_cmp_le_u32 vcc, v217, v244
    v_mov_b32 v218, 0xf149f2ca
    v_cndmask_b32 v158, v218, v158, vcc
    v_add_u32 v217, 59, v216
    v_cmp_le_u32 vcc, v217, v244
    v_mov_b32 v218, 0xf149f2ca
    v_cndmask_b32 v159, v218, v159, vcc
at_nomask_1:
    v_max3_f32 v216, v128, v129, v130
    v_max3_f32 v216, v216, v131, v132
    v_max3_f32 v216, v216, v133, v134
    v_max3_f32 v216, v216, v135, v136
    v_max3_f32 v216, v216, v137, v138
    v_max3_f32 v216, v216, v139, v140
    v_max3_f32 v216, v216, v141, v142
    v_max3_f32 v216, v216, v143, v144
    v_max3_f32 v216, v216, v145, v146
    v_max3_f32 v216, v216, v147, v148
    v_max3_f32 v216, v216, v149, v150
    v_max3_f32 v216, v216, v151, v152
    v_max3_f32 v216, v216, v153, v154
    v_max3_f32 v216, v216, v155, v156
    v_max3_f32 v216, v216, v157, v158
    v_max_f32 v216, v216, v159
    v_mov_b32 v217, v216
    s_nop 1
    v_permlane32_swap_b32 v216, v217
    s_nop 1
    v_max3_f32 v216, v216, v217, v240
    v_sub_f32 v242, v240, v216
    v_mul_f32 v242, 0.09016844005556021, v242
    v_exp_f32 v242, v242
    v_mov_b32 v240, v216
    v_mul_f32 v217, -0.09016844005556021, v216
    s_mov_b32 s36, 0.09016844005556021
    v_mul_f32 v241, v241, v242

    v_fma_f32 v128, v128, s36, v217
    v_exp_f32 v128, v128
    v_fma_f32 v129, v129, s36, v217
    v_exp_f32 v129, v129
    v_fma_f32 v130, v130, s36, v217
    v_exp_f32 v130, v130
    v_fma_f32 v131, v131, s36, v217
    v_exp_f32 v131, v131
    v_fma_f32 v132, v132, s36, v217
    v_exp_f32 v132, v132
    v_fma_f32 v133, v133, s36, v217
    v_exp_f32 v133, v133
    v_fma_f32 v134, v134, s36, v217
    v_exp_f32 v134, v134
    v_fma_f32 v135, v135, s36, v217
    v_exp_f32 v135, v135
    v_fma_f32 v136, v136, s36, v217
    v_exp_f32 v136, v136
    v_fma_f32 v137, v137, s36, v217
    v_exp_f32 v137, v137
    v_fma_f32 v138, v138, s36, v217
    v_exp_f32 v138, v138
    v_fma_f32 v139, v139, s36, v217
    v_exp_f32 v139, v139
    v_fma_f32 v140, v140, s36, v217
    v_exp_f32 v140, v140
    v_fma_f32 v141, v141, s36, v217
    v_exp_f32 v141, v141
    v_fma_f32 v142, v142, s36, v217
    v_exp_f32 v142, v142
    v_fma_f32 v143, v143, s36, v217
    v_exp_f32 v143, v143
    v_fma_f32 v144, v144, s36, v217
    v_exp_f32 v144, v144
    v_fma_f32 v145, v145, s36, v217
    v_exp_f32 v145, v145
    v_fma_f32 v146, v146, s36, v217
    v_exp_f32 v146, v146
    v_fma_f32 v147, v147, s36, v217
    v_exp_f32 v147, v147
    v_fma_f32 v148, v148, s36, v217
    v_exp_f32 v148, v148
    v_fma_f32 v149, v149, s36, v217
    v_exp_f32 v149, v149
    v_fma_f32 v150, v150, s36, v217
    v_exp_f32 v150, v150
    v_fma_f32 v151, v151, s36, v217
    v_exp_f32 v151, v151
    v_fma_f32 v152, v152, s36, v217
    v_exp_f32 v152, v152
    v_fma_f32 v153, v153, s36, v217
    v_exp_f32 v153, v153
    v_fma_f32 v154, v154, s36, v217
    v_exp_f32 v154, v154
    v_fma_f32 v155, v155, s36, v217
    v_exp_f32 v155, v155
    v_fma_f32 v156, v156, s36, v217
    v_exp_f32 v156, v156
    v_fma_f32 v157, v157, s36, v217
    v_exp_f32 v157, v157
    v_fma_f32 v158, v158, s36, v217
    v_exp_f32 v158, v158
    v_fma_f32 v159, v159, s36, v217
    v_exp_f32 v159, v159
    s_nop 0
    v_add_f32 v241, v241, v128
    v_add_f32 v241, v241, v129
    v_add_f32 v241, v241, v130
    v_add_f32 v241, v241, v131
    v_add_f32 v241, v241, v132
    v_add_f32 v241, v241, v133
    v_add_f32 v241, v241, v134
    v_add_f32 v241, v241, v135
    v_add_f32 v241, v241, v136
    v_add_f32 v241, v241, v137
    v_add_f32 v241, v241, v138
    v_add_f32 v241, v241, v139
    v_add_f32 v241, v241, v140
    v_add_f32 v241, v241, v141
    v_add_f32 v241, v241, v142
    v_add_f32 v241, v241, v143
    v_add_f32 v241, v241, v144
    v_add_f32 v241, v241, v145
    v_add_f32 v241, v241, v146
    v_add_f32 v241, v241, v147
    v_add_f32 v241, v241, v148
    v_add_f32 v241, v241, v149
    v_add_f32 v241, v241, v150
    v_add_f32 v241, v241, v151
    v_add_f32 v241, v241, v152
    v_add_f32 v241, v241, v153
    v_add_f32 v241, v241, v154
    v_add_f32 v241, v241, v155
    v_add_f32 v241, v241, v156
    v_add_f32 v241, v241, v157
    v_add_f32 v241, v241, v158
    v_add_f32 v241, v241, v159
    v_cvt_pk_bf16_f32 v160, v128, v129
    v_cvt_pk_bf16_f32 v161, v130, v131
    v_cvt_pk_bf16_f32 v162, v132, v133
    v_cvt_pk_bf16_f32 v163, v134, v135
    v_cvt_pk_bf16_f32 v164, v136, v137
    v_cvt_pk_bf16_f32 v165, v138, v139
    v_cvt_pk_bf16_f32 v166, v140, v141
    v_cvt_pk_bf16_f32 v167, v142, v143
    v_cvt_pk_bf16_f32 v168, v144, v145
    v_cvt_pk_bf16_f32 v169, v146, v147
    v_cvt_pk_bf16_f32 v170, v148, v149
    v_cvt_pk_bf16_f32 v171, v150, v151
    v_cvt_pk_bf16_f32 v172, v152, v153
    v_cvt_pk_bf16_f32 v173, v154, v155
    v_cvt_pk_bf16_f32 v174, v156, v157
    v_cvt_pk_bf16_f32 v175, v158, v159
    v_pk_mul_f32 v[0:1], v[0:1], v[242:243] op_sel_hi:[1,0]
    v_pk_mul_f32 v[2:3], v[2:3], v[242:243] op_sel_hi:[1,0]
    v_pk_mul_f32 v[4:5], v[4:5], v[242:243] op_sel_hi:[1,0]
    v_pk_mul_f32 v[6:7], v[6:7], v[242:243] op_sel_hi:[1,0]
    v_pk_mul_f32 v[8:9], v[8:9], v[242:243] op_sel_hi:[1,0]
    v_pk_mul_f32 v[10:11], v[10:11], v[242:243] op_sel_hi:[1,0]
    v_pk_mul_f32 v[12:13], v[12:13], v[242:243] op_sel_hi:[1,0]
    v_pk_mul_f32 v[14:15], v[14:15], v[242:243] op_sel_hi:[1,0]
    v_pk_mul_f32 v[16:17], v[16:17], v[242:243] op_sel_hi:[1,0]
    v_pk_mul_f32 v[18:19], v[18:19], v[242:243] op_sel_hi:[1,0]
    v_pk_mul_f32 v[20:21], v[20:21], v[242:243] op_sel_hi:[1,0]
    v_pk_mul_f32 v[22:23], v[22:23], v[242:243] op_sel_hi:[1,0]
    v_pk_mul_f32 v[24:25], v[24:25], v[242:243] op_sel_hi:[1,0]
    v_pk_mul_f32 v[26:27], v[26:27], v[242:243] op_sel_hi:[1,0]
    v_pk_mul_f32 v[28:29], v[28:29], v[242:243] op_sel_hi:[1,0]
    v_pk_mul_f32 v[30:31], v[30:31], v[242:243] op_sel_hi:[1,0]
    v_pk_mul_f32 v[32:33], v[32:33], v[242:243] op_sel_hi:[1,0]
    v_pk_mul_f32 v[34:35], v[34:35], v[242:243] op_sel_hi:[1,0]
    v_pk_mul_f32 v[36:37], v[36:37], v[242:243] op_sel_hi:[1,0]
    v_pk_mul_f32 v[38:39], v[38:39], v[242:243] op_sel_hi:[1,0]
    v_pk_mul_f32 v[40:41], v[40:41], v[242:243] op_sel_hi:[1,0]
    v_pk_mul_f32 v[42:43], v[42:43], v[242:243] op_sel_hi:[1,0]
    v_pk_mul_f32 v[44:45], v[44:45], v[242:243] op_sel_hi:[1,0]
    v_pk_mul_f32 v[46:47], v[46:47], v[242:243] op_sel_hi:[1,0]
    v_pk_mul_f32 v[48:49], v[48:49], v[242:243] op_sel_hi:[1,0]
    v_pk_mul_f32 v[50:51], v[50:51], v[242:243] op_sel_hi:[1,0]
    v_pk_mul_f32 v[52:53], v[52:53], v[242:243] op_sel_hi:[1,0]
    v_pk_mul_f32 v[54:55], v[54:55], v[242:243] op_sel_hi:[1,0]
    v_pk_mul_f32 v[56:57], v[56:57], v[242:243] op_sel_hi:[1,0]
    v_pk_mul_f32 v[58:59], v[58:59], v[242:243] op_sel_hi:[1,0]
    v_pk_mul_f32 v[60:61], v[60:61], v[242:243] op_sel_hi:[1,0]
    v_pk_mul_f32 v[62:63], v[62:63], v[242:243] op_sel_hi:[1,0]
    v_pk_mul_f32 v[64:65], v[64:65], v[242:243] op_sel_hi:[1,0]
    v_pk_mul_f32 v[66:67], v[66:67], v[242:243] op_sel_hi:[1,0]
    v_pk_mul_f32 v[68:69], v[68:69], v[242:243] op_sel_hi:[1,0]
    v_pk_mul_f32 v[70:71], v[70:71], v[242:243] op_sel_hi:[1,0]
    v_pk_mul_f32 v[72:73], v[72:73], v[242:243] op_sel_hi:[1,0]
    v_pk_mul_f32 v[74:75], v[74:75], v[242:243] op_sel_hi:[1,0]
    v_pk_mul_f32 v[76:77], v[76:77], v[242:243] op_sel_hi:[1,0]
    v_pk_mul_f32 v[78:79], v[78:79], v[242:243] op_sel_hi:[1,0]
    v_pk_mul_f32 v[80:81], v[80:81], v[242:243] op_sel_hi:[1,0]
    v_pk_mul_f32 v[82:83], v[82:83], v[242:243] op_sel_hi:[1,0]
    v_pk_mul_f32 v[84:85], v[84:85], v[242:243] op_sel_hi:[1,0]
    v_pk_mul_f32 v[86:87], v[86:87], v[242:243] op_sel_hi:[1,0]
    v_pk_mul_f32 v[88:89], v[88:89], v[242:243] op_sel_hi:[1,0]
    v_pk_mul_f32 v[90:91], v[90:91], v[242:243] op_sel_hi:[1,0]
    v_pk_mul_f32 v[92:93], v[92:93], v[242:243] op_sel_hi:[1,0]
    v_pk_mul_f32 v[94:95], v[94:95], v[242:243] op_sel_hi:[1,0]
    v_pk_mul_f32 v[96:97], v[96:97], v[242:243] op_sel_hi:[1,0]
    v_pk_mul_f32 v[98:99], v[98:99], v[242:243] op_sel_hi:[1,0]
    v_pk_mul_f32 v[100:101], v[100:101], v[242:243] op_sel_hi:[1,0]
    v_pk_mul_f32 v[102:103], v[102:103], v[242:243] op_sel_hi:[1,0]
    v_pk_mul_f32 v[104:105], v[104:105], v[242:243] op_sel_hi:[1,0]
    v_pk_mul_f32 v[106:107], v[106:107], v[242:243] op_sel_hi:[1,0]
    v_pk_mul_f32 v[108:109], v[108:109], v[242:243] op_sel_hi:[1,0]
    v_pk_mul_f32 v[110:111], v[110:111], v[242:243] op_sel_hi:[1,0]
    v_pk_mul_f32 v[112:113], v[112:113], v[242:243] op_sel_hi:[1,0]
    v_pk_mul_f32 v[114:115], v[114:115], v[242:243] op_sel_hi:[1,0]
    v_pk_mul_f32 v[116:117], v[116:117], v[242:243] op_sel_hi:[1,0]
    v_pk_mul_f32 v[118:119], v[118:119], v[242:243] op_sel_hi:[1,0]
    v_pk_mul_f32 v[120:121], v[120:121], v[242:243] op_sel_hi:[1,0]
    v_pk_mul_f32 v[122:123], v[122:123], v[242:243] op_sel_hi:[1,0]
    v_pk_mul_f32 v[124:125], v[124:125], v[242:243] op_sel_hi:[1,0]
    v_pk_mul_f32 v[126:127], v[126:127], v[242:243] op_sel_hi:[1,0]
    s_nop 1
    ds_read_b64_tr_b16 a[92:93], v195 offset:0
    ds_read_b64_tr_b16 a[94:95], v195 offset:4096
    s_waitcnt lgkmcnt(6)
    v_mfma_f32_32x32x16_bf16 v[0:15], a[80:83], v[160:163], v[0:15]
    ds_read_b64_tr_b16 a[80:81], v192 offset:256
    ds_read_b64_tr_b16 a[82:83], v192 offset:4352
    s_waitcnt lgkmcnt(6)
    v_mfma_f32_32x32x16_bf16 v[16:31], a[84:87], v[160:163], v[16:31]
    ds_read_b64_tr_b16 a[84:85], v193 offset:256
    ds_read_b64_tr_b16 a[86:87], v193 offset:4352
    s_waitcnt lgkmcnt(6)
    v_mfma_f32_32x32x16_bf16 v[32:47], a[88:91], v[160:163], v[32:47]
    ds_read_b64_tr_b16 a[88:89], v194 offset:256
    ds_read_b64_tr_b16 a[90:91], v194 offset:4352
    s_waitcnt lgkmcnt(6)
    v_mfma_f32_32x32x16_bf16 v[48:63], a[92:95], v[160:163], v[48:63]
    ds_read_b64_tr_b16 a[92:93], v195 offset:256
    ds_read_b64_tr_b16 a[94:95], v195 offset:4352
    s_waitcnt lgkmcnt(6)
    v_mfma_f32_32x32x16_bf16 v[64:79], a[80:83], v[160:163], v[64:79]
    ds_read_b64_tr_b16 a[80:81], v192 offset:8192
    ds_read_b64_tr_b16 a[82:83], v192 offset:12288
    s_waitcnt lgkmcnt(6)
    v_mfma_f32_32x32x16_bf16 v[80:95], a[84:87], v[160:163], v[80:95]
    ds_read_b64_tr_b16 a[84:85], v193 offset:8192
    ds_read_b64_tr_b16 a[86:87], v193 offset:12288
    s_waitcnt lgkmcnt(6)
    v_mfma_f32_32x32x16_bf16 v[96:111], a[88:91], v[160:163], v[96:111]
    ds_read_b64_tr_b16 a[88:89], v194 offset:8192
    ds_read_b64_tr_b16 a[90:91], v194 offset:12288
    s_waitcnt lgkmcnt(6)
    v_mfma_f32_32x32x16_bf16 v[112:127], a[92:95], v[160:163], v[112:127]
    ds_read_b64_tr_b16 a[92:93], v195 offset:8192
    ds_read_b64_tr_b16 a[94:95], v195 offset:12288
    s_waitcnt lgkmcnt(6)
    v_mfma_f32_32x32x16_bf16 v[0:15], a[80:83], v[164:167], v[0:15]
    ds_read_b64_tr_b16 a[80:81], v192 offset:8448
    ds_read_b64_tr_b16 a[82:83], v192 offset:12544
    s_waitcnt lgkmcnt(6)
    v_mfma_f32_32x32x16_bf16 v[16:31], a[84:87], v[164:167], v[16:31]
    ds_read_b64_tr_b16 a[84:85], v193 offset:8448
    ds_read_b64_tr_b16 a[86:87], v193 offset:12544
    s_waitcnt lgkmcnt(6)
    v_mfma_f32_32x32x16_bf16 v[32:47], a[88:91], v[164:167], v[32:47]
    ds_read_b64_tr_b16 a[88:89], v194 offset:8448
    ds_read_b64_tr_b16 a[90:91], v194 offset:12544
    s_waitcnt lgkmcnt(6)
    v_mfma_f32_32x32x16_bf16 v[48:63], a[92:95], v[164:167], v[48:63]
    ds_read_b64_tr_b16 a[92:93], v195 offset:8448
    ds_read_b64_tr_b16 a[94:95], v195 offset:12544
    s_waitcnt lgkmcnt(6)
    v_mfma_f32_32x32x16_bf16 v[64:79], a[80:83], v[164:167], v[64:79]
    ds_read_b64_tr_b16 a[80:81], v192 offset:16384
    ds_read_b64_tr_b16 a[82:83], v192 offset:20480
    s_waitcnt lgkmcnt(6)
    v_mfma_f32_32x32x16_bf16 v[80:95], a[84:87], v[164:167], v[80:95]
    ds_read_b64_tr_b16 a[84:85], v193 offset:16384
    ds_read_b64_tr_b16 a[86:87], v193 offset:20480
    s_waitcnt lgkmcnt(6)
    v_mfma_f32_32x32x16_bf16 v[96:111], a[88:91], v[164:167], v[96:111]
    ds_read_b64_tr_b16 a[88:89], v194 offset:16384
    ds_read_b64_tr_b16 a[90:91], v194 offset:20480
    s_waitcnt lgkmcnt(6)
    v_mfma_f32_32x32x16_bf16 v[112:127], a[92:95], v[164:167], v[112:127]
    ds_read_b64_tr_b16 a[92:93], v195 offset:16384
    ds_read_b64_tr_b16 a[94:95], v195 offset:20480
    s_waitcnt lgkmcnt(6)
    v_mfma_f32_32x32x16_bf16 v[0:15], a[80:83], v[168:171], v[0:15]
    ds_read_b64_tr_b16 a[80:81], v192 offset:16640
    ds_read_b64_tr_b16 a[82:83], v192 offset:20736
    s_waitcnt lgkmcnt(6)
    v_mfma_f32_32x32x16_bf16 v[16:31], a[84:87], v[168:171], v[16:31]
    ds_read_b64_tr_b16 a[84:85], v193 offset:16640
    ds_read_b64_tr_b16 a[86:87], v193 offset:20736
    s_waitcnt lgkmcnt(6)
    v_mfma_f32_32x32x16_bf16 v[32:47], a[88:91], v[168:171], v[32:47]
    ds_read_b64_tr_b16 a[88:89], v194 offset:16640
    ds_read_b64_tr_b16 a[90:91], v194 offset:20736
    s_waitcnt lgkmcnt(6)
    v_mfma_f32_32x32x16_bf16 v[48:63], a[92:95], v[168:171], v[48:63]
    ds_read_b64_tr_b16 a[92:93], v195 offset:16640
    ds_read_b64_tr_b16 a[94:95], v195 offset:20736
    s_waitcnt lgkmcnt(6)
    v_mfma_f32_32x32x16_bf16 v[64:79], a[80:83], v[168:171], v[64:79]
    ds_read_b64_tr_b16 a[80:81], v192 offset:24576
    ds_read_b64_tr_b16 a[82:83], v192 offset:28672
    s_waitcnt lgkmcnt(6)
    v_mfma_f32_32x32x16_bf16 v[80:95], a[84:87], v[168:171], v[80:95]
    ds_read_b64_tr_b16 a[84:85], v193 offset:24576
    ds_read_b64_tr_b16 a[86:87], v193 offset:28672
    s_waitcnt lgkmcnt(6)
    v_mfma_f32_32x32x16_bf16 v[96:111], a[88:91], v[168:171], v[96:111]
    ds_read_b64_tr_b16 a[88:89], v194 offset:24576
    ds_read_b64_tr_b16 a[90:91], v194 offset:28672
    s_waitcnt lgkmcnt(6)
    v_mfma_f32_32x32x16_bf16 v[112:127], a[92:95], v[168:171], v[112:127]
    ds_read_b64_tr_b16 a[92:93], v195 offset:24576
    ds_read_b64_tr_b16 a[94:95], v195 offset:28672
    s_waitcnt lgkmcnt(6)
    v_mfma_f32_32x32x16_bf16 v[0:15], a[80:83], v[172:175], v[0:15]
    ds_read_b64_tr_b16 a[80:81], v192 offset:24832
    ds_read_b64_tr_b16 a[82:83], v192 offset:28928
    s_waitcnt lgkmcnt(6)
    v_mfma_f32_32x32x16_bf16 v[16:31], a[84:87], v[172:175], v[16:31]
    ds_read_b64_tr_b16 a[84:85], v193 offset:24832
    ds_read_b64_tr_b16 a[86:87], v193 offset:28928
    s_waitcnt lgkmcnt(6)
    v_mfma_f32_32x32x16_bf16 v[32:47], a[88:91], v[172:175], v[32:47]
    ds_read_b64_tr_b16 a[88:89], v194 offset:24832
    ds_read_b64_tr_b16 a[90:91], v194 offset:28928
    s_waitcnt lgkmcnt(6)
    v_mfma_f32_32x32x16_bf16 v[48:63], a[92:95], v[172:175], v[48:63]
    ds_read_b64_tr_b16 a[92:93], v195 offset:24832
    ds_read_b64_tr_b16 a[94:95], v195 offset:28928
    s_waitcnt lgkmcnt(6)
    v_mfma_f32_32x32x16_bf16 v[64:79], a[80:83], v[172:175], v[64:79]
    s_waitcnt lgkmcnt(4)
    v_mfma_f32_32x32x16_bf16 v[80:95], a[84:87], v[172:175], v[80:95]
    s_waitcnt lgkmcnt(2)
    v_mfma_f32_32x32x16_bf16 v[96:111], a[88:91], v[172:175], v[96:111]
    s_waitcnt lgkmcnt(0)
    v_mfma_f32_32x32x16_bf16 v[112:127], a[92:95], v[172:175], v[112:127]
    s_add_u32 s35, s35, 1
    s_cmp_ge_u32 s35, s34
    s_cbranch_scc1 at_epi
    s_waitcnt vmcnt(0)
    s_barrier
    s_add_u32 s36, s35, 1
    s_cmp_ge_u32 s36, s34
    s_cbranch_scc1 at_nodma1
    s_add_u32 m0, s32, 0
    s_nop 0
    buffer_load_dwordx4 v200, s[12:15], s33 offen lds
    s_add_u32 m0, s32, 1024
    s_nop 0
    buffer_load_dwordx4 v201, s[12:15], s33 offen lds
    s_add_u32 m0, s32, 2048
    s_nop 0
    buffer_load_dwordx4 v202, s[12:15], s33 offen lds
    s_add_u32 m0, s32, 3072
    s_nop 0
    buffer_load_dwordx4 v203, s[12:15], s33 offen lds
    s_add_u32 m0, s32, 4096
    s_nop 0
    buffer_load_dwordx4 v204, s[12:15], s33 offen lds
    s_add_u32 m0, s32, 5120
    s_nop 0
    buffer_load_dwordx4 v205, s[12:15], s33 offen lds
    s_add_u32 m0, s32, 6144
    s_nop 0
    buffer_load_dwordx4 v206, s[12:15], s33 offen lds
    s_add_u32 m0, s32, 7168
    s_nop 0
    buffer_load_dwordx4 v207, s[12:15], s33 offen lds
    s_add_u32 m0, s32, 32768
    s_nop 0
    buffer_load_dwordx4 v208, s[16:19], s33 offen lds
    s_add_u32 m0, s32, 33792
    s_nop 0
    buffer_load_dwordx4 v209, s[16:19], s33 offen lds
    s_add_u32 m0, s32, 34816
    s_nop 0
    buffer_load_dwordx4 v210, s[16:19], s33 offen lds
    s_add_u32 m0, s32, 35840
    s_nop 0
    buffer_load_dwordx4 v211, s[16:19], s33 offen lds
    s_add_u32 m0, s32, 36864
    s_nop 0
    buffer_load_dwordx4 v212, s[16:19], s33 offen lds
    s_add_u32 m0, s32, 37888
    s_nop 0
    buffer_load_dwordx4 v213, s[16:19], s33 offen lds
    s_add_u32 m0, s32, 38912
    s_nop 0
    buffer_load_dwordx4 v214, s[16:19], s33 offen lds
    s_add_u32 m0, s32, 39936
    s_nop 0
    buffer_load_dwordx4 v215, s[16:19], s33 offen lds
    s_add_u32 s33, s33, 32768
at_nodma1:
    v_mov_b32 v128, 0
    v_mov_b32 v129, 0
    v_mov_b32 v130, 0
    v_mov_b32 v131, 0
    v_mov_b32 v132, 0
    v_mov_b32 v133, 0
    v_mov_b32 v134, 0
    v_mov_b32 v135, 0
    v_mov_b32 v136, 0
    v_mov_b32 v137, 0
    v_mov_b32 v138, 0
    v_mov_b32 v139, 0
    v_mov_b32 v140, 0
    v_mov_b32 v141, 0
    v_mov_b32 v142, 0
    v_mov_b32 v143, 0
    v_mov_b32 v144, 0
    v_mov_b32 v145, 0
    v_mov_b32 v146, 0
    v_mov_b32 v147, 0
    v_mov_b32 v148, 0
    v_mov_b32 v149, 0
    v_mov_b32 v150, 0
    v_mov_b32 v151, 0
    v_mov_b32 v152, 0
    v_mov_b32 v153, 0
    v_mov_b32 v154, 0
    v_mov_b32 v155, 0
    v_mov_b32 v156, 0
    v_mov_b32 v157, 0
    v_mov_b32 v158, 0
    v_mov_b32 v159, 0
    ds_read_b128 a[64:67], v184 offset:0
    ds_read_b128 a[68:71], v185 offset:0
    ds_read_b128 a[72:75], v186 offset:0
    ds_read_b128 a[76:79], v187 offset:0
    s_waitcnt lgkmcnt(3)
    v_mfma_f32_32x32x16_bf16 v[128:143], a[64:67], a[0:3], v[128:143]
    ds_read_b128 a[64:67], v188 offset:0
    s_waitcnt lgkmcnt(3)
    v_mfma_f32_32x32x16_bf16 v[128:143], a[68:71], a[4:7], v[128:143]
    ds_read_b128 a[68:71], v189 offset:0
    s_waitcnt lgkmcnt(3)
    v_mfma_f32_32x32x16_bf16 v[128:143], a[72:75], a[8:11], v[128:143]
    ds_read_b128 a[72:75], v190 offset:0
    s_waitcnt lgkmcnt(3)
    v_mfma_f32_32x32x16_bf16 v[128:143], a[76:79], a[12:15], v[128:143]
    ds_read_b128 a[76:79], v191 offset:0
    s_waitcnt lgkmcnt(3)
    v_mfma_f32_32x32x16_bf16 v[128:143], a[64:67], a[16:19], v[128:143]
    ds_read_b128 a[64:67], v184 offset:256
    s_waitcnt lgkmcnt(3)
    v_mfma_f32_32x32x16_bf16 v[128:143], a[68:71], a[20:23], v[128:143]
    ds_read_b128 a[68:71], v185 offset:256
    s_waitcnt lgkmcnt(3)
    v_mfma_f32_32x32x16_bf16 v[128:143], a[72:75], a[24:27], v[128:143]
    ds_read_b128 a[72:75], v186 offset:256
    s_waitcnt lgkmcnt(3)
    v_mfma_f32_32x32x16_bf16 v[128:143], a[76:79], a[28:31], v[128:143]
    ds_read_b128 a[76:79], v187 offset:256
    s_waitcnt lgkmcnt(3)
    v_mfma_f32_32x32x16_bf16 v[128:143], a[64:67], a[32:35], v[128:143]
    ds_read_b128 a[64:67], v188 offset:256
    s_waitcnt lgkmcnt(3)
    v_mfma_f32_32x32x16_bf16 v[128:143], a[68:71], a[36:39], v[128:143]
    ds_read_b128 a[68:71], v189 offset:256
    s_waitcnt lgkmcnt(3)
    v_mfma_f32_32x32x16_bf16 v[128:143], a[72:75], a[40:43], v[128:143]
    ds_read_b128 a[72:75], v190 offset:256
    s_waitcnt lgkmcnt(3)
    v_mfma_f32_32x32x16_bf16 v[128:143], a[76:79], a[44:47], v[128:143]
    ds_read_b128 a[76:79], v191 offset:256
    s_waitcnt lgkmcnt(3)
    v_mfma_f32_32x32x16_bf16 v[128:143], a[64:67], a[48:51], v[128:143]
    ds_read_b128 a[64:67], v184 offset:16384
    s_waitcnt lgkmcnt(3)
    v_mfma_f32_32x32x16_bf16 v[128:143], a[68:71], a[52:55], v[128:143]
    ds_read_b128 a[68:71], v185 offset:16384
    s_waitcnt lgkmcnt(3)
    v_mfma_f32_32x32x16_bf16 v[128:143], a[72:75], a[56:59], v[128:143]
    ds_read_b128 a[72:75], v186 offset:16384
    s_waitcnt lgkmcnt(3)
    v_mfma_f32_32x32x16_bf16 v[128:143], a[76:79], a[60:63], v[128:143]
    ds_read_b128 a[76:79], v187 offset:16384
    s_waitcnt lgkmcnt(3)
    v_mfma_f32_32x32x16_bf16 v[144:159], a[64:67], a[0:3], v[144:159]
    ds_read_b128 a[64:67], v188 offset:16384
    s_waitcnt lgkmcnt(3)
    v_mfma_f32_32x32x16_bf16 v[144:159], a[68:71], a[4:7], v[144:159]
    ds_read_b128 a[68:71], v189 offset:16384
    s_waitcnt lgkmcnt(3)
    v_mfma_f32_32x32x16_bf16 v[144:159], a[72:75], a[8:11], v[144:159]
    ds_read_b128 a[72:75], v190 offset:16384
    s_waitcnt lgkmcnt(3)
    v_mfma_f32_32x32x16_bf16 v[144:159], a[76:79], a[12:15], v[144:159]
    ds_read_b128 a[76:79], v191 offset:16384
    s_waitcnt lgkmcnt(3)
    v_mfma_f32_32x32x16_bf16 v[144:159], a[64:67], a[16:19], v[144:159]
    ds_read_b128 a[64:67], v184 offset:16640
    s_waitcnt lgkmcnt(3)
    v_mfma_f32_32x32x16_bf16 v[144:159], a[68:71], a[20:23], v[144:159]
    ds_read_b128 a[68:71], v185 offset:16640
    s_waitcnt lgkmcnt(3)
    v_mfma_f32_32x32x16_bf16 v[144:159], a[72:75], a[24:27], v[144:159]
    ds_read_b128 a[72:75], v186 offset:16640
    s_waitcnt lgkmcnt(3)
    v_mfma_f32_32x32x16_bf16 v[144:159], a[76:79], a[28:31], v[144:159]
    ds_read_b128 a[76:79], v187 offset:16640
    s_waitcnt lgkmcnt(3)
    v_mfma_f32_32x32x16_bf16 v[144:159], a[64:67], a[32:35], v[144:159]
    ds_read_b128 a[64:67], v188 offset:16640
    s_waitcnt lgkmcnt(3)
    v_mfma_f32_32x32x16_bf16 v[144:159], a[68:71], a[36:39], v[144:159]
    ds_read_b128 a[68:71], v189 offset:16640
    s_waitcnt lgkmcnt(3)
    v_mfma_f32_32x32x16_bf16 v[144:159], a[72:75], a[40:43], v[144:159]
    ds_read_b128 a[72:75], v190 offset:16640
    s_waitcnt lgkmcnt(3)
    v_mfma_f32_32x32x16_bf16 v[144:159], a[76:79], a[44:47], v[144:159]
    ds_read_b128 a[76:79], v191 offset:16640
    s_waitcnt lgkmcnt(3)
    v_mfma_f32_32x32x16_bf16 v[144:159], a[64:67], a[48:51], v[144:159]
    s_waitcnt lgkmcnt(2)
    v_mfma_f32_32x32x16_bf16 v[144:159], a[68:71], a[52:55], v[144:159]
    s_waitcnt lgkmcnt(1)
    v_mfma_f32_32x32x16_bf16 v[144:159], a[72:75], a[56:59], v[144:159]
    s_waitcnt lgkmcnt(0)
    v_mfma_f32_32x32x16_bf16 v[144:159], a[76:79], a[60:63], v[144:159]
    ds_read_b64_tr_b16 a[80:81], v196 offset:0
    ds_read_b64_tr_b16 a[82:83], v196 offset:4096
    ds_read_b64_tr_b16 a[84:85], v197 offset:0
    ds_read_b64_tr_b16 a[86:87], v197 offset:4096
    ds_read_b64_tr_b16 a[88:89], v198 offset:0
    ds_read_b64_tr_b16 a[90:91], v198 offset:4096
    s_nop 7
    s_nop 7
    s_add_u32 s36, s35, 2
    s_cmp_lt_u32 s36, s34
    s_cbranch_scc1 at_nomask_2
    s_lshl_b32 s36, s35, 6
    v_lshrrev_b32 v216, 5, v243
    v_lshlrev_b32 v216, 2, v216
    v_add_u32 v216, s36, v216

    v_add_u32 v217, 0, v216
    v_cmp_le_u32 vcc, v217, v244
    v_mov_b32 v218, 0xf149f2ca
    v_cndmask_b32 v128, v218, v128, vcc
    v_add_u32 v217, 1, v216
    v_cmp_le_u32 vcc, v217, v244
    v_mov_b32 v218, 0xf149f2ca
    v_cndmask_b32 v129, v218, v129, vcc
    v_add_u32 v217, 2, v216
    v_cmp_le_u32 vcc, v217, v244
    v_mov_b32 v218, 0xf149f2ca
    v_cndmask_b32 v130, v218, v130, vcc
    v_add_u32 v217, 3, v216
    v_cmp_le_u32 vcc, v217, v244
    v_mov_b32 v218, 0xf149f2ca
    v_cndmask_b32 v131, v218, v131, vcc
    v_add_u32 v217, 8, v216
    v_cmp_le_u32 vcc, v217, v244
    v_mov_b32 v218, 0xf149f2ca
    v_cndmask_b32 v132, v218, v132, vcc
    v_add_u32 v217, 9, v216
    v_cmp_le_u32 vcc, v217, v244
    v_mov_b32 v218, 0xf149f2ca
    v_cndmask_b32 v133, v218, v133, vcc
    v_add_u32 v217, 10, v216
    v_cmp_le_u32 vcc, v217, v244
    v_mov_b32 v218, 0xf149f2ca
    v_cndmask_b32 v134, v218, v134, vcc
    v_add_u32 v217, 11, v216
    v_cmp_le_u32 vcc, v217, v244
    v_mov_b32 v218, 0xf149f2ca
    v_cndmask_b32 v135, v218, v135, vcc
    v_add_u32 v217, 16, v216
    v_cmp_le_u32 vcc, v217, v244
    v_mov_b32 v218, 0xf149f2ca
    v_cndmask_b32 v136, v218, v136, vcc
    v_add_u32 v217, 17, v216
    v_cmp_le_u32 vcc, v217, v244
    v_mov_b32 v218, 0xf149f2ca
    v_cndmask_b32 v137, v218, v137, vcc
    v_add_u32 v217, 18, v216
    v_cmp_le_u32 vcc, v217, v244
    v_mov_b32 v218, 0xf149f2ca
    v_cndmask_b32 v138, v218, v138, vcc
    v_add_u32 v217, 19, v216
    v_cmp_le_u32 vcc, v217, v244
    v_mov_b32 v218, 0xf149f2ca
    v_cndmask_b32 v139, v218, v139, vcc
    v_add_u32 v217, 24, v216
    v_cmp_le_u32 vcc, v217, v244
    v_mov_b32 v218, 0xf149f2ca
    v_cndmask_b32 v140, v218, v140, vcc
    v_add_u32 v217, 25, v216
    v_cmp_le_u32 vcc, v217, v244
    v_mov_b32 v218, 0xf149f2ca
    v_cndmask_b32 v141, v218, v141, vcc
    v_add_u32 v217, 26, v216
    v_cmp_le_u32 vcc, v217, v244
    v_mov_b32 v218, 0xf149f2ca
    v_cndmask_b32 v142, v218, v142, vcc
    v_add_u32 v217, 27, v216
    v_cmp_le_u32 vcc, v217, v244
    v_mov_b32 v218, 0xf149f2ca
    v_cndmask_b32 v143, v218, v143, vcc
    v_add_u32 v217, 32, v216
    v_cmp_le_u32 vcc, v217, v244
    v_mov_b32 v218, 0xf149f2ca
    v_cndmask_b32 v144, v218, v144, vcc
    v_add_u32 v217, 33, v216
    v_cmp_le_u32 vcc, v217, v244
    v_mov_b32 v218, 0xf149f2ca
    v_cndmask_b32 v145, v218, v145, vcc
    v_add_u32 v217, 34, v216
    v_cmp_le_u32 vcc, v217, v244
    v_mov_b32 v218, 0xf149f2ca
    v_cndmask_b32 v146, v218, v146, vcc
    v_add_u32 v217, 35, v216
    v_cmp_le_u32 vcc, v217, v244
    v_mov_b32 v218, 0xf149f2ca
    v_cndmask_b32 v147, v218, v147, vcc
    v_add_u32 v217, 40, v216
    v_cmp_le_u32 vcc, v217, v244
    v_mov_b32 v218, 0xf149f2ca
    v_cndmask_b32 v148, v218, v148, vcc
    v_add_u32 v217, 41, v216
    v_cmp_le_u32 vcc, v217, v244
    v_mov_b32 v218, 0xf149f2ca
    v_cndmask_b32 v149, v218, v149, vcc
    v_add_u32 v217, 42, v216
    v_cmp_le_u32 vcc, v217, v244
    v_mov_b32 v218, 0xf149f2ca
    v_cndmask_b32 v150, v218, v150, vcc
    v_add_u32 v217, 43, v216
    v_cmp_le_u32 vcc, v217, v244
    v_mov_b32 v218, 0xf149f2ca
    v_cndmask_b32 v151, v218, v151, vcc
    v_add_u32 v217, 48, v216
    v_cmp_le_u32 vcc, v217, v244
    v_mov_b32 v218, 0xf149f2ca
    v_cndmask_b32 v152, v218, v152, vcc
    v_add_u32 v217, 49, v216
    v_cmp_le_u32 vcc, v217, v244
    v_mov_b32 v218, 0xf149f2ca
    v_cndmask_b32 v153, v218, v153, vcc
    v_add_u32 v217, 50, v216
    v_cmp_le_u32 vcc, v217, v244
    v_mov_b32 v218, 0xf149f2ca
    v_cndmask_b32 v154, v218, v154, vcc
    v_add_u32 v217, 51, v216
    v_cmp_le_u32 vcc, v217, v244
    v_mov_b32 v218, 0xf149f2ca
    v_cndmask_b32 v155, v218, v155, vcc
    v_add_u32 v217, 56, v216
    v_cmp_le_u32 vcc, v217, v244
    v_mov_b32 v218, 0xf149f2ca
    v_cndmask_b32 v156, v218, v156, vcc
    v_add_u32 v217, 57, v216
    v_cmp_le_u32 vcc, v217, v244
    v_mov_b32 v218, 0xf149f2ca
    v_cndmask_b32 v157, v218, v157, vcc
    v_add_u32 v217, 58, v216
    v_cmp_le_u32 vcc, v217, v244
    v_mov_b32 v218, 0xf149f2ca
    v_cndmask_b32 v158, v218, v158, vcc
    v_add_u32 v217, 59, v216
    v_cmp_le_u32 vcc, v217, v244
    v_mov_b32 v218, 0xf149f2ca
    v_cndmask_b32 v159, v218, v159, vcc
at_nomask_2:
    v_max3_f32 v216, v128, v129, v130
    v_max3_f32 v216, v216, v131, v132
    v_max3_f32 v216, v216, v133, v134
    v_max3_f32 v216, v216, v135, v136
    v_max3_f32 v216, v216, v137, v138
    v_max3_f32 v216, v216, v139, v140
    v_max3_f32 v216, v216, v141, v142
    v_max3_f32 v216, v216, v143, v144
    v_max3_f32 v216, v216, v145, v146
    v_max3_f32 v216, v216, v147, v148
    v_max3_f32 v216, v216, v149, v150
    v_max3_f32 v216, v216, v151, v152
    v_max3_f32 v216, v216, v153, v154
    v_max3_f32 v216, v216, v155, v156
    v_max3_f32 v216, v216, v157, v158
    v_max_f32 v216, v216, v159
    v_mov_b32 v217, v216
    s_nop 1
    v_permlane32_swap_b32 v216, v217
    s_nop 1
    v_max3_f32 v216, v216, v217, v240
    v_sub_f32 v242, v240, v216
    v_mul_f32 v242, 0.09016844005556021, v242
    v_exp_f32 v242, v242
    v_mov_b32 v240, v216
    v_mul_f32 v217, -0.09016844005556021, v216
    s_mov_b32 s36, 0.09016844005556021
    v_mul_f32 v241, v241, v242

    v_fma_f32 v128, v128, s36, v217
    v_exp_f32 v128, v128
    v_fma_f32 v129, v129, s36, v217
    v_exp_f32 v129, v129
    v_fma_f32 v130, v130, s36, v217
    v_exp_f32 v130, v130
    v_fma_f32 v131, v131, s36, v217
    v_exp_f32 v131, v131
    v_fma_f32 v132, v132, s36, v217
    v_exp_f32 v132, v132
    v_fma_f32 v133, v133, s36, v217
    v_exp_f32 v133, v133
    v_fma_f32 v134, v134, s36, v217
    v_exp_f32 v134, v134
    v_fma_f32 v135, v135, s36, v217
    v_exp_f32 v135, v135
    v_fma_f32 v136, v136, s36, v217
    v_exp_f32 v136, v136
    v_fma_f32 v137, v137, s36, v217
    v_exp_f32 v137, v137
    v_fma_f32 v138, v138, s36, v217
    v_exp_f32 v138, v138
    v_fma_f32 v139, v139, s36, v217
    v_exp_f32 v139, v139
    v_fma_f32 v140, v140, s36, v217
    v_exp_f32 v140, v140
    v_fma_f32 v141, v141, s36, v217
    v_exp_f32 v141, v141
    v_fma_f32 v142, v142, s36, v217
    v_exp_f32 v142, v142
    v_fma_f32 v143, v143, s36, v217
    v_exp_f32 v143, v143
    v_fma_f32 v144, v144, s36, v217
    v_exp_f32 v144, v144
    v_fma_f32 v145, v145, s36, v217
    v_exp_f32 v145, v145
    v_fma_f32 v146, v146, s36, v217
    v_exp_f32 v146, v146
    v_fma_f32 v147, v147, s36, v217
    v_exp_f32 v147, v147
    v_fma_f32 v148, v148, s36, v217
    v_exp_f32 v148, v148
    v_fma_f32 v149, v149, s36, v217
    v_exp_f32 v149, v149
    v_fma_f32 v150, v150, s36, v217
    v_exp_f32 v150, v150
    v_fma_f32 v151, v151, s36, v217
    v_exp_f32 v151, v151
    v_fma_f32 v152, v152, s36, v217
    v_exp_f32 v152, v152
    v_fma_f32 v153, v153, s36, v217
    v_exp_f32 v153, v153
    v_fma_f32 v154, v154, s36, v217
    v_exp_f32 v154, v154
    v_fma_f32 v155, v155, s36, v217
    v_exp_f32 v155, v155
    v_fma_f32 v156, v156, s36, v217
    v_exp_f32 v156, v156
    v_fma_f32 v157, v157, s36, v217
    v_exp_f32 v157, v157
    v_fma_f32 v158, v158, s36, v217
    v_exp_f32 v158, v158
    v_fma_f32 v159, v159, s36, v217
    v_exp_f32 v159, v159
    s_nop 0
    v_add_f32 v241, v241, v128
    v_add_f32 v241, v241, v129
    v_add_f32 v241, v241, v130
    v_add_f32 v241, v241, v131
    v_add_f32 v241, v241, v132
    v_add_f32 v241, v241, v133
    v_add_f32 v241, v241, v134
    v_add_f32 v241, v241, v135
    v_add_f32 v241, v241, v136
    v_add_f32 v241, v241, v137
    v_add_f32 v241, v241, v138
    v_add_f32 v241, v241, v139
    v_add_f32 v241, v241, v140
    v_add_f32 v241, v241, v141
    v_add_f32 v241, v241, v142
    v_add_f32 v241, v241, v143
    v_add_f32 v241, v241, v144
    v_add_f32 v241, v241, v145
    v_add_f32 v241, v241, v146
    v_add_f32 v241, v241, v147
    v_add_f32 v241, v241, v148
    v_add_f32 v241, v241, v149
    v_add_f32 v241, v241, v150
    v_add_f32 v241, v241, v151
    v_add_f32 v241, v241, v152
    v_add_f32 v241, v241, v153
    v_add_f32 v241, v241, v154
    v_add_f32 v241, v241, v155
    v_add_f32 v241, v241, v156
    v_add_f32 v241, v241, v157
    v_add_f32 v241, v241, v158
    v_add_f32 v241, v241, v159
    v_cvt_pk_bf16_f32 v160, v128, v129
    v_cvt_pk_bf16_f32 v161, v130, v131
    v_cvt_pk_bf16_f32 v162, v132, v133
    v_cvt_pk_bf16_f32 v163, v134, v135
    v_cvt_pk_bf16_f32 v164, v136, v137
    v_cvt_pk_bf16_f32 v165, v138, v139
    v_cvt_pk_bf16_f32 v166, v140, v141
    v_cvt_pk_bf16_f32 v167, v142, v143
    v_cvt_pk_bf16_f32 v168, v144, v145
    v_cvt_pk_bf16_f32 v169, v146, v147
    v_cvt_pk_bf16_f32 v170, v148, v149
    v_cvt_pk_bf16_f32 v171, v150, v151
    v_cvt_pk_bf16_f32 v172, v152, v153
    v_cvt_pk_bf16_f32 v173, v154, v155
    v_cvt_pk_bf16_f32 v174, v156, v157
    v_cvt_pk_bf16_f32 v175, v158, v159
    v_pk_mul_f32 v[0:1], v[0:1], v[242:243] op_sel_hi:[1,0]
    v_pk_mul_f32 v[2:3], v[2:3], v[242:243] op_sel_hi:[1,0]
    v_pk_mul_f32 v[4:5], v[4:5], v[242:243] op_sel_hi:[1,0]
    v_pk_mul_f32 v[6:7], v[6:7], v[242:243] op_sel_hi:[1,0]
    v_pk_mul_f32 v[8:9], v[8:9], v[242:243] op_sel_hi:[1,0]
    v_pk_mul_f32 v[10:11], v[10:11], v[242:243] op_sel_hi:[1,0]
    v_pk_mul_f32 v[12:13], v[12:13], v[242:243] op_sel_hi:[1,0]
    v_pk_mul_f32 v[14:15], v[14:15], v[242:243] op_sel_hi:[1,0]
    v_pk_mul_f32 v[16:17], v[16:17], v[242:243] op_sel_hi:[1,0]
    v_pk_mul_f32 v[18:19], v[18:19], v[242:243] op_sel_hi:[1,0]
    v_pk_mul_f32 v[20:21], v[20:21], v[242:243] op_sel_hi:[1,0]
    v_pk_mul_f32 v[22:23], v[22:23], v[242:243] op_sel_hi:[1,0]
    v_pk_mul_f32 v[24:25], v[24:25], v[242:243] op_sel_hi:[1,0]
    v_pk_mul_f32 v[26:27], v[26:27], v[242:243] op_sel_hi:[1,0]
    v_pk_mul_f32 v[28:29], v[28:29], v[242:243] op_sel_hi:[1,0]
    v_pk_mul_f32 v[30:31], v[30:31], v[242:243] op_sel_hi:[1,0]
    v_pk_mul_f32 v[32:33], v[32:33], v[242:243] op_sel_hi:[1,0]
    v_pk_mul_f32 v[34:35], v[34:35], v[242:243] op_sel_hi:[1,0]
    v_pk_mul_f32 v[36:37], v[36:37], v[242:243] op_sel_hi:[1,0]
    v_pk_mul_f32 v[38:39], v[38:39], v[242:243] op_sel_hi:[1,0]
    v_pk_mul_f32 v[40:41], v[40:41], v[242:243] op_sel_hi:[1,0]
    v_pk_mul_f32 v[42:43], v[42:43], v[242:243] op_sel_hi:[1,0]
    v_pk_mul_f32 v[44:45], v[44:45], v[242:243] op_sel_hi:[1,0]
    v_pk_mul_f32 v[46:47], v[46:47], v[242:243] op_sel_hi:[1,0]
    v_pk_mul_f32 v[48:49], v[48:49], v[242:243] op_sel_hi:[1,0]
    v_pk_mul_f32 v[50:51], v[50:51], v[242:243] op_sel_hi:[1,0]
    v_pk_mul_f32 v[52:53], v[52:53], v[242:243] op_sel_hi:[1,0]
    v_pk_mul_f32 v[54:55], v[54:55], v[242:243] op_sel_hi:[1,0]
    v_pk_mul_f32 v[56:57], v[56:57], v[242:243] op_sel_hi:[1,0]
    v_pk_mul_f32 v[58:59], v[58:59], v[242:243] op_sel_hi:[1,0]
    v_pk_mul_f32 v[60:61], v[60:61], v[242:243] op_sel_hi:[1,0]
    v_pk_mul_f32 v[62:63], v[62:63], v[242:243] op_sel_hi:[1,0]
    v_pk_mul_f32 v[64:65], v[64:65], v[242:243] op_sel_hi:[1,0]
    v_pk_mul_f32 v[66:67], v[66:67], v[242:243] op_sel_hi:[1,0]
    v_pk_mul_f32 v[68:69], v[68:69], v[242:243] op_sel_hi:[1,0]
    v_pk_mul_f32 v[70:71], v[70:71], v[242:243] op_sel_hi:[1,0]
    v_pk_mul_f32 v[72:73], v[72:73], v[242:243] op_sel_hi:[1,0]
    v_pk_mul_f32 v[74:75], v[74:75], v[242:243] op_sel_hi:[1,0]
    v_pk_mul_f32 v[76:77], v[76:77], v[242:243] op_sel_hi:[1,0]
    v_pk_mul_f32 v[78:79], v[78:79], v[242:243] op_sel_hi:[1,0]
    v_pk_mul_f32 v[80:81], v[80:81], v[242:243] op_sel_hi:[1,0]
    v_pk_mul_f32 v[82:83], v[82:83], v[242:243] op_sel_hi:[1,0]
    v_pk_mul_f32 v[84:85], v[84:85], v[242:243] op_sel_hi:[1,0]
    v_pk_mul_f32 v[86:87], v[86:87], v[242:243] op_sel_hi:[1,0]
    v_pk_mul_f32 v[88:89], v[88:89], v[242:243] op_sel_hi:[1,0]
    v_pk_mul_f32 v[90:91], v[90:91], v[242:243] op_sel_hi:[1,0]
    v_pk_mul_f32 v[92:93], v[92:93], v[242:243] op_sel_hi:[1,0]
    v_pk_mul_f32 v[94:95], v[94:95], v[242:243] op_sel_hi:[1,0]
    v_pk_mul_f32 v[96:97], v[96:97], v[242:243] op_sel_hi:[1,0]
    v_pk_mul_f32 v[98:99], v[98:99], v[242:243] op_sel_hi:[1,0]
    v_pk_mul_f32 v[100:101], v[100:101], v[242:243] op_sel_hi:[1,0]
    v_pk_mul_f32 v[102:103], v[102:103], v[242:243] op_sel_hi:[1,0]
    v_pk_mul_f32 v[104:105], v[104:105], v[242:243] op_sel_hi:[1,0]
    v_pk_mul_f32 v[106:107], v[106:107], v[242:243] op_sel_hi:[1,0]
    v_pk_mul_f32 v[108:109], v[108:109], v[242:243] op_sel_hi:[1,0]
    v_pk_mul_f32 v[110:111], v[110:111], v[242:243] op_sel_hi:[1,0]
    v_pk_mul_f32 v[112:113], v[112:113], v[242:243] op_sel_hi:[1,0]
    v_pk_mul_f32 v[114:115], v[114:115], v[242:243] op_sel_hi:[1,0]
    v_pk_mul_f32 v[116:117], v[116:117], v[242:243] op_sel_hi:[1,0]
    v_pk_mul_f32 v[118:119], v[118:119], v[242:243] op_sel_hi:[1,0]
    v_pk_mul_f32 v[120:121], v[120:121], v[242:243] op_sel_hi:[1,0]
    v_pk_mul_f32 v[122:123], v[122:123], v[242:243] op_sel_hi:[1,0]
    v_pk_mul_f32 v[124:125], v[124:125], v[242:243] op_sel_hi:[1,0]
    v_pk_mul_f32 v[126:127], v[126:127], v[242:243] op_sel_hi:[1,0]
    s_nop 1
    ds_read_b64_tr_b16 a[92:93], v199 offset:0
    ds_read_b64_tr_b16 a[94:95], v199 offset:4096
    s_waitcnt lgkmcnt(6)
    v_mfma_f32_32x32x16_bf16 v[0:15], a[80:83], v[160:163], v[0:15]
    ds_read_b64_tr_b16 a[80:81], v196 offset:256
    ds_read_b64_tr_b16 a[82:83], v196 offset:4352
    s_waitcnt lgkmcnt(6)
    v_mfma_f32_32x32x16_bf16 v[16:31], a[84:87], v[160:163], v[16:31]
    ds_read_b64_tr_b16 a[84:85], v197 offset:256
    ds_read_b64_tr_b16 a[86:87], v197 offset:4352
    s_waitcnt lgkmcnt(6)
    v_mfma_f32_32x32x16_bf16 v[32:47], a[88:91], v[160:163], v[32:47]
    ds_read_b64_tr_b16 a[88:89], v198 offset:256
    ds_read_b64_tr_b16 a[90:91], v198 offset:4352
    s_waitcnt lgkmcnt(6)
    v_mfma_f32_32x32x16_bf16 v[48:63], a[92:95], v[160:163], v[48:63]
    ds_read_b64_tr_b16 a[92:93], v199 offset:256
    ds_read_b64_tr_b16 a[94:95], v199 offset:4352
    s_waitcnt lgkmcnt(6)
    v_mfma_f32_32x32x16_bf16 v[64:79], a[80:83], v[160:163], v[64:79]
    ds_read_b64_tr_b16 a[80:81], v196 offset:8192
    ds_read_b64_tr_b16 a[82:83], v196 offset:12288
    s_waitcnt lgkmcnt(6)
    v_mfma_f32_32x32x16_bf16 v[80:95], a[84:87], v[160:163], v[80:95]
    ds_read_b64_tr_b16 a[84:85], v197 offset:8192
    ds_read_b64_tr_b16 a[86:87], v197 offset:12288
    s_waitcnt lgkmcnt(6)
    v_mfma_f32_32x32x16_bf16 v[96:111], a[88:91], v[160:163], v[96:111]
    ds_read_b64_tr_b16 a[88:89], v198 offset:8192
    ds_read_b64_tr_b16 a[90:91], v198 offset:12288
    s_waitcnt lgkmcnt(6)
    v_mfma_f32_32x32x16_bf16 v[112:127], a[92:95], v[160:163], v[112:127]
    ds_read_b64_tr_b16 a[92:93], v199 offset:8192
    ds_read_b64_tr_b16 a[94:95], v199 offset:12288
    s_waitcnt lgkmcnt(6)
    v_mfma_f32_32x32x16_bf16 v[0:15], a[80:83], v[164:167], v[0:15]
    ds_read_b64_tr_b16 a[80:81], v196 offset:8448
    ds_read_b64_tr_b16 a[82:83], v196 offset:12544
    s_waitcnt lgkmcnt(6)
    v_mfma_f32_32x32x16_bf16 v[16:31], a[84:87], v[164:167], v[16:31]
    ds_read_b64_tr_b16 a[84:85], v197 offset:8448
    ds_read_b64_tr_b16 a[86:87], v197 offset:12544
    s_waitcnt lgkmcnt(6)
    v_mfma_f32_32x32x16_bf16 v[32:47], a[88:91], v[164:167], v[32:47]
    ds_read_b64_tr_b16 a[88:89], v198 offset:8448
    ds_read_b64_tr_b16 a[90:91], v198 offset:12544
    s_waitcnt lgkmcnt(6)
    v_mfma_f32_32x32x16_bf16 v[48:63], a[92:95], v[164:167], v[48:63]
    ds_read_b64_tr_b16 a[92:93], v199 offset:8448
    ds_read_b64_tr_b16 a[94:95], v199 offset:12544
    s_waitcnt lgkmcnt(6)
    v_mfma_f32_32x32x16_bf16 v[64:79], a[80:83], v[164:167], v[64:79]
    ds_read_b64_tr_b16 a[80:81], v196 offset:16384
    ds_read_b64_tr_b16 a[82:83], v196 offset:20480
    s_waitcnt lgkmcnt(6)
    v_mfma_f32_32x32x16_bf16 v[80:95], a[84:87], v[164:167], v[80:95]
    ds_read_b64_tr_b16 a[84:85], v197 offset:16384
    ds_read_b64_tr_b16 a[86:87], v197 offset:20480
    s_waitcnt lgkmcnt(6)
    v_mfma_f32_32x32x16_bf16 v[96:111], a[88:91], v[164:167], v[96:111]
    ds_read_b64_tr_b16 a[88:89], v198 offset:16384
    ds_read_b64_tr_b16 a[90:91], v198 offset:20480
    s_waitcnt lgkmcnt(6)
    v_mfma_f32_32x32x16_bf16 v[112:127], a[92:95], v[164:167], v[112:127]
    ds_read_b64_tr_b16 a[92:93], v199 offset:16384
    ds_read_b64_tr_b16 a[94:95], v199 offset:20480
    s_waitcnt lgkmcnt(6)
    v_mfma_f32_32x32x16_bf16 v[0:15], a[80:83], v[168:171], v[0:15]
    ds_read_b64_tr_b16 a[80:81], v196 offset:16640
    ds_read_b64_tr_b16 a[82:83], v196 offset:20736
    s_waitcnt lgkmcnt(6)
    v_mfma_f32_32x32x16_bf16 v[16:31], a[84:87], v[168:171], v[16:31]
    ds_read_b64_tr_b16 a[84:85], v197 offset:16640
    ds_read_b64_tr_b16 a[86:87], v197 offset:20736
    s_waitcnt lgkmcnt(6)
    v_mfma_f32_32x32x16_bf16 v[32:47], a[88:91], v[168:171], v[32:47]
    ds_read_b64_tr_b16 a[88:89], v198 offset:16640
    ds_read_b64_tr_b16 a[90:91], v198 offset:20736
    s_waitcnt lgkmcnt(6)
    v_mfma_f32_32x32x16_bf16 v[48:63], a[92:95], v[168:171], v[48:63]
    ds_read_b64_tr_b16 a[92:93], v199 offset:16640
    ds_read_b64_tr_b16 a[94:95], v199 offset:20736
    s_waitcnt lgkmcnt(6)
    v_mfma_f32_32x32x16_bf16 v[64:79], a[80:83], v[168:171], v[64:79]
    ds_read_b64_tr_b16 a[80:81], v196 offset:24576
    ds_read_b64_tr_b16 a[82:83], v196 offset:28672
    s_waitcnt lgkmcnt(6)
    v_mfma_f32_32x32x16_bf16 v[80:95], a[84:87], v[168:171], v[80:95]
    ds_read_b64_tr_b16 a[84:85], v197 offset:24576
    ds_read_b64_tr_b16 a[86:87], v197 offset:28672
    s_waitcnt lgkmcnt(6)
    v_mfma_f32_32x32x16_bf16 v[96:111], a[88:91], v[168:171], v[96:111]
    ds_read_b64_tr_b16 a[88:89], v198 offset:24576
    ds_read_b64_tr_b16 a[90:91], v198 offset:28672
    s_waitcnt lgkmcnt(6)
    v_mfma_f32_32x32x16_bf16 v[112:127], a[92:95], v[168:171], v[112:127]
    ds_read_b64_tr_b16 a[92:93], v199 offset:24576
    ds_read_b64_tr_b16 a[94:95], v199 offset:28672
    s_waitcnt lgkmcnt(6)
    v_mfma_f32_32x32x16_bf16 v[0:15], a[80:83], v[172:175], v[0:15]
    ds_read_b64_tr_b16 a[80:81], v196 offset:24832
    ds_read_b64_tr_b16 a[82:83], v196 offset:28928
    s_waitcnt lgkmcnt(6)
    v_mfma_f32_32x32x16_bf16 v[16:31], a[84:87], v[172:175], v[16:31]
    ds_read_b64_tr_b16 a[84:85], v197 offset:24832
    ds_read_b64_tr_b16 a[86:87], v197 offset:28928
    s_waitcnt lgkmcnt(6)
    v_mfma_f32_32x32x16_bf16 v[32:47], a[88:91], v[172:175], v[32:47]
    ds_read_b64_tr_b16 a[88:89], v198 offset:24832
    ds_read_b64_tr_b16 a[90:91], v198 offset:28928
    s_waitcnt lgkmcnt(6)
    v_mfma_f32_32x32x16_bf16 v[48:63], a[92:95], v[172:175], v[48:63]
    ds_read_b64_tr_b16 a[92:93], v199 offset:24832
    ds_read_b64_tr_b16 a[94:95], v199 offset:28928
    s_waitcnt lgkmcnt(6)
    v_mfma_f32_32x32x16_bf16 v[64:79], a[80:83], v[172:175], v[64:79]
    s_waitcnt lgkmcnt(4)
    v_mfma_f32_32x32x16_bf16 v[80:95], a[84:87], v[172:175], v[80:95]
    s_waitcnt lgkmcnt(2)
    v_mfma_f32_32x32x16_bf16 v[96:111], a[88:91], v[172:175], v[96:111]
    s_waitcnt lgkmcnt(0)
    v_mfma_f32_32x32x16_bf16 v[112:127], a[92:95], v[172:175], v[112:127]
    s_add_u32 s35, s35, 1
    s_cmp_ge_u32 s35, s34
    s_cbranch_scc0 at_loop
at_epi:
    s_nop 7
    s_nop 7
    s_nop 7
    v_mov_b32 v217, v241
    s_nop 1
    v_permlane32_swap_b32 v241, v217
    s_nop 1
    v_add_f32 v241, v241, v217
    v_rcp_f32 v242, v241
    v_lshlrev_b32 v217, 13, v244
    v_lshrrev_b32 v218, 5, v243
    v_lshl_add_u32 v217, v218, 3, v217
    s_lshl_b32 s36, s20, 9
    v_add_u32 v217, s36, v217

    v_mul_f32 v0, v0, v242
    v_mul_f32 v1, v1, v242
    v_mul_f32 v2, v2, v242
    v_mul_f32 v3, v3, v242
    v_cvt_pk_bf16_f32 v220, v0, v1
    v_cvt_pk_bf16_f32 v221, v2, v3
    buffer_store_dwordx2 v[220:221], v217, s[28:31], 0 offen offset:0
    v_mul_f32 v4, v4, v242
    v_mul_f32 v5, v5, v242
    v_mul_f32 v6, v6, v242
    v_mul_f32 v7, v7, v242
    v_cvt_pk_bf16_f32 v222, v4, v5
    v_cvt_pk_bf16_f32 v223, v6, v7
    buffer_store_dwordx2 v[222:223], v217, s[28:31], 0 offen offset:16
    v_mul_f32 v8, v8, v242
    v_mul_f32 v9, v9, v242
    v_mul_f32 v10, v10, v242
    v_mul_f32 v11, v11, v242
    v_cvt_pk_bf16_f32 v220, v8, v9
    v_cvt_pk_bf16_f32 v221, v10, v11
    buffer_store_dwordx2 v[220:221], v217, s[28:31], 0 offen offset:32
    v_mul_f32 v12, v12, v242
    v_mul_f32 v13, v13, v242
    v_mul_f32 v14, v14, v242
    v_mul_f32 v15, v15, v242
    v_cvt_pk_bf16_f32 v222, v12, v13
    v_cvt_pk_bf16_f32 v223, v14, v15
    buffer_store_dwordx2 v[222:223], v217, s[28:31], 0 offen offset:48
    v_mul_f32 v16, v16, v242
    v_mul_f32 v17, v17, v242
    v_mul_f32 v18, v18, v242
    v_mul_f32 v19, v19, v242
    v_cvt_pk_bf16_f32 v220, v16, v17
    v_cvt_pk_bf16_f32 v221, v18, v19
    buffer_store_dwordx2 v[220:221], v217, s[28:31], 0 offen offset:64
    v_mul_f32 v20, v20, v242
    v_mul_f32 v21, v21, v242
    v_mul_f32 v22, v22, v242
    v_mul_f32 v23, v23, v242
    v_cvt_pk_bf16_f32 v222, v20, v21
    v_cvt_pk_bf16_f32 v223, v22, v23
    buffer_store_dwordx2 v[222:223], v217, s[28:31], 0 offen offset:80
    v_mul_f32 v24, v24, v242
    v_mul_f32 v25, v25, v242
    v_mul_f32 v26, v26, v242
    v_mul_f32 v27, v27, v242
    v_cvt_pk_bf16_f32 v220, v24, v25
    v_cvt_pk_bf16_f32 v221, v26, v27
    buffer_store_dwordx2 v[220:221], v217, s[28:31], 0 offen offset:96
    v_mul_f32 v28, v28, v242
    v_mul_f32 v29, v29, v242
    v_mul_f32 v30, v30, v242
    v_mul_f32 v31, v31, v242
    v_cvt_pk_bf16_f32 v222, v28, v29
    v_cvt_pk_bf16_f32 v223, v30, v31
    buffer_store_dwordx2 v[222:223], v217, s[28:31], 0 offen offset:112
    v_mul_f32 v32, v32, v242
    v_mul_f32 v33, v33, v242
    v_mul_f32 v34, v34, v242
    v_mul_f32 v35, v35, v242
    v_cvt_pk_bf16_f32 v220, v32, v33
    v_cvt_pk_bf16_f32 v221, v34, v35
    buffer_store_dwordx2 v[220:221], v217, s[28:31], 0 offen offset:128
    v_mul_f32 v36, v36, v242
    v_mul_f32 v37, v37, v242
    v_mul_f32 v38, v38, v242
    v_mul_f32 v39, v39, v242
    v_cvt_pk_bf16_f32 v222, v36, v37
    v_cvt_pk_bf16_f32 v223, v38, v39
    buffer_store_dwordx2 v[222:223], v217, s[28:31], 0 offen offset:144
    v_mul_f32 v40, v40, v242
    v_mul_f32 v41, v41, v242
    v_mul_f32 v42, v42, v242
    v_mul_f32 v43, v43, v242
    v_cvt_pk_bf16_f32 v220, v40, v41
    v_cvt_pk_bf16_f32 v221, v42, v43
    buffer_store_dwordx2 v[220:221], v217, s[28:31], 0 offen offset:160
    v_mul_f32 v44, v44, v242
    v_mul_f32 v45, v45, v242
    v_mul_f32 v46, v46, v242
    v_mul_f32 v47, v47, v242
    v_cvt_pk_bf16_f32 v222, v44, v45
    v_cvt_pk_bf16_f32 v223, v46, v47
    buffer_store_dwordx2 v[222:223], v217, s[28:31], 0 offen offset:176
    v_mul_f32 v48, v48, v242
    v_mul_f32 v49, v49, v242
    v_mul_f32 v50, v50, v242
    v_mul_f32 v51, v51, v242
    v_cvt_pk_bf16_f32 v220, v48, v49
    v_cvt_pk_bf16_f32 v221, v50, v51
    buffer_store_dwordx2 v[220:221], v217, s[28:31], 0 offen offset:192
    v_mul_f32 v52, v52, v242
    v_mul_f32 v53, v53, v242
    v_mul_f32 v54, v54, v242
    v_mul_f32 v55, v55, v242
    v_cvt_pk_bf16_f32 v222, v52, v53
    v_cvt_pk_bf16_f32 v223, v54, v55
    buffer_store_dwordx2 v[222:223], v217, s[28:31], 0 offen offset:208
    v_mul_f32 v56, v56, v242
    v_mul_f32 v57, v57, v242
    v_mul_f32 v58, v58, v242
    v_mul_f32 v59, v59, v242
    v_cvt_pk_bf16_f32 v220, v56, v57
    v_cvt_pk_bf16_f32 v221, v58, v59
    buffer_store_dwordx2 v[220:221], v217, s[28:31], 0 offen offset:224
    v_mul_f32 v60, v60, v242
    v_mul_f32 v61, v61, v242
    v_mul_f32 v62, v62, v242
    v_mul_f32 v63, v63, v242
    v_cvt_pk_bf16_f32 v222, v60, v61
    v_cvt_pk_bf16_f32 v223, v62, v63
    buffer_store_dwordx2 v[222:223], v217, s[28:31], 0 offen offset:240
    v_mul_f32 v64, v64, v242
    v_mul_f32 v65, v65, v242
    v_mul_f32 v66, v66, v242
    v_mul_f32 v67, v67, v242
    v_cvt_pk_bf16_f32 v220, v64, v65
    v_cvt_pk_bf16_f32 v221, v66, v67
    buffer_store_dwordx2 v[220:221], v217, s[28:31], 0 offen offset:256
    v_mul_f32 v68, v68, v242
    v_mul_f32 v69, v69, v242
    v_mul_f32 v70, v70, v242
    v_mul_f32 v71, v71, v242
    v_cvt_pk_bf16_f32 v222, v68, v69
    v_cvt_pk_bf16_f32 v223, v70, v71
    buffer_store_dwordx2 v[222:223], v217, s[28:31], 0 offen offset:272
    v_mul_f32 v72, v72, v242
    v_mul_f32 v73, v73, v242
    v_mul_f32 v74, v74, v242
    v_mul_f32 v75, v75, v242
    v_cvt_pk_bf16_f32 v220, v72, v73
    v_cvt_pk_bf16_f32 v221, v74, v75
    buffer_store_dwordx2 v[220:221], v217, s[28:31], 0 offen offset:288
    v_mul_f32 v76, v76, v242
    v_mul_f32 v77, v77, v242
    v_mul_f32 v78, v78, v242
    v_mul_f32 v79, v79, v242
    v_cvt_pk_bf16_f32 v222, v76, v77
    v_cvt_pk_bf16_f32 v223, v78, v79
    buffer_store_dwordx2 v[222:223], v217, s[28:31], 0 offen offset:304
    v_mul_f32 v80, v80, v242
    v_mul_f32 v81, v81, v242
    v_mul_f32 v82, v82, v242
    v_mul_f32 v83, v83, v242
    v_cvt_pk_bf16_f32 v220, v80, v81
    v_cvt_pk_bf16_f32 v221, v82, v83
    buffer_store_dwordx2 v[220:221], v217, s[28:31], 0 offen offset:320
    v_mul_f32 v84, v84, v242
    v_mul_f32 v85, v85, v242
    v_mul_f32 v86, v86, v242
    v_mul_f32 v87, v87, v242
    v_cvt_pk_bf16_f32 v222, v84, v85
    v_cvt_pk_bf16_f32 v223, v86, v87
    buffer_store_dwordx2 v[222:223], v217, s[28:31], 0 offen offset:336
    v_mul_f32 v88, v88, v242
    v_mul_f32 v89, v89, v242
    v_mul_f32 v90, v90, v242
    v_mul_f32 v91, v91, v242
    v_cvt_pk_bf16_f32 v220, v88, v89
    v_cvt_pk_bf16_f32 v221, v90, v91
    buffer_store_dwordx2 v[220:221], v217, s[28:31], 0 offen offset:352
    v_mul_f32 v92, v92, v242
    v_mul_f32 v93, v93, v242
    v_mul_f32 v94, v94, v242
    v_mul_f32 v95, v95, v242
    v_cvt_pk_bf16_f32 v222, v92, v93
    v_cvt_pk_bf16_f32 v223, v94, v95
    buffer_store_dwordx2 v[222:223], v217, s[28:31], 0 offen offset:368
    v_mul_f32 v96, v96, v242
    v_mul_f32 v97, v97, v242
    v_mul_f32 v98, v98, v242
    v_mul_f32 v99, v99, v242
    v_cvt_pk_bf16_f32 v220, v96, v97
    v_cvt_pk_bf16_f32 v221, v98, v99
    buffer_store_dwordx2 v[220:221], v217, s[28:31], 0 offen offset:384
    v_mul_f32 v100, v100, v242
    v_mul_f32 v101, v101, v242
    v_mul_f32 v102, v102, v242
    v_mul_f32 v103, v103, v242
    v_cvt_pk_bf16_f32 v222, v100, v101
    v_cvt_pk_bf16_f32 v223, v102, v103
    buffer_store_dwordx2 v[222:223], v217, s[28:31], 0 offen offset:400
    v_mul_f32 v104, v104, v242
    v_mul_f32 v105, v105, v242
    v_mul_f32 v106, v106, v242
    v_mul_f32 v107, v107, v242
    v_cvt_pk_bf16_f32 v220, v104, v105
    v_cvt_pk_bf16_f32 v221, v106, v107
    buffer_store_dwordx2 v[220:221], v217, s[28:31], 0 offen offset:416
    v_mul_f32 v108, v108, v242
    v_mul_f32 v109, v109, v242
    v_mul_f32 v110, v110, v242
    v_mul_f32 v111, v111, v242
    v_cvt_pk_bf16_f32 v222, v108, v109
    v_cvt_pk_bf16_f32 v223, v110, v111
    buffer_store_dwordx2 v[222:223], v217, s[28:31], 0 offen offset:432
    v_mul_f32 v112, v112, v242
    v_mul_f32 v113, v113, v242
    v_mul_f32 v114, v114, v242
    v_mul_f32 v115, v115, v242
    v_cvt_pk_bf16_f32 v220, v112, v113
    v_cvt_pk_bf16_f32 v221, v114, v115
    buffer_store_dwordx2 v[220:221], v217, s[28:31], 0 offen offset:448
    v_mul_f32 v116, v116, v242
    v_mul_f32 v117, v117, v242
    v_mul_f32 v118, v118, v242
    v_mul_f32 v119, v119, v242
    v_cvt_pk_bf16_f32 v222, v116, v117
    v_cvt_pk_bf16_f32 v223, v118, v119
    buffer_store_dwordx2 v[222:223], v217, s[28:31], 0 offen offset:464
    v_mul_f32 v120, v120, v242
    v_mul_f32 v121, v121, v242
    v_mul_f32 v122, v122, v242
    v_mul_f32 v123, v123, v242
    v_cvt_pk_bf16_f32 v220, v120, v121
    v_cvt_pk_bf16_f32 v221, v122, v123
    buffer_store_dwordx2 v[220:221], v217, s[28:31], 0 offen offset:480
    v_mul_f32 v124, v124, v242
    v_mul_f32 v125, v125, v242
    v_mul_f32 v126, v126, v242
    v_mul_f32 v127, v127, v242
    v_cvt_pk_bf16_f32 v222, v124, v125
    v_cvt_pk_bf16_f32 v223, v126, v127
    buffer_store_dwordx2 v[222:223], v217, s[28:31], 0 offen offset:496
at_done:
    s_endpgm

.globl out_kernel
.p2align 8
.type out_kernel,@function
out_kernel:

    s_cmp_ge_u32 s2, 224
    s_cbranch_scc1 ok_done
    s_load_dwordx2 s[4:5], s[0:1], 96
    s_load_dwordx2 s[6:7], s[0:1], 40
    s_load_dwordx2 s[26:27], s[0:1], 72
    s_load_dwordx2 s[28:29], s[0:1], 0
    s_load_dwordx2 s[30:31], s[0:1], 80
    v_lshrrev_b32 v1, 6, v0
    v_and_b32 v2, 63, v0
    s_nop 0
    v_readfirstlane_b32 s24, v1
    s_lshr_b32 s38, s2, 3
    s_and_b32 s39, s2, 7
    s_waitcnt lgkmcnt(0)

    s_mul_hi_u32 s38, s2, 0x24924925
    s_sub_u32 s39, s2, s38
    s_lshr_b32 s39, s39, 1
    s_add_u32 s38, s38, s39
    s_lshr_b32 s38, s38, 2
    s_mul_i32 s39, s38, 7
    s_sub_u32 s39, s2, s39
    s_lshl_b32 s46, s38, 6
    s_lshl_b32 s47, s39, 6
    s_lshl_b32 s25, s24, 12

    v_mov_b32 v64, 0
    v_mov_b32 v65, 0
    v_mov_b32 v66, 0
    v_mov_b32 v67, 0
    v_mov_b32 v68, 0
    v_mov_b32 v69, 0
    v_mov_b32 v70, 0
    v_mov_b32 v71, 0
    v_mov_b32 v72, 0
    v_mov_b32 v73, 0
    v_mov_b32 v74, 0
    v_mov_b32 v75, 0
    v_mov_b32 v76, 0
    v_mov_b32 v77, 0
    v_mov_b32 v78, 0
    v_mov_b32 v79, 0
    v_mov_b32 v80, 0
    v_mov_b32 v81, 0
    v_mov_b32 v82, 0
    v_mov_b32 v83, 0
    v_mov_b32 v84, 0
    v_mov_b32 v85, 0
    v_mov_b32 v86, 0
    v_mov_b32 v87, 0
    v_mov_b32 v88, 0
    v_mov_b32 v89, 0
    v_mov_b32 v90, 0
    v_mov_b32 v91, 0
    v_mov_b32 v92, 0
    v_mov_b32 v93, 0
    v_mov_b32 v94, 0
    v_mov_b32 v95, 0
    s_and_b32 s50, s24, 1
    s_lshr_b32 s51, s24, 1
    v_and_b32 v3, 31, v2
    s_lshl_b32 s49, s51, 5
    v_add_u32 v3, s49, v3
    v_and_b32 v4, 15, v3
    v_lshrrev_b32 v5, 5, v2
    v_lshlrev_b32 v3, 8, v3

    v_add_u32 v6, 0, v5
    v_xor_b32 v6, v6, v4
    v_lshl_add_u32 v10, v6, 4, v3

    v_add_u32 v6, 2, v5
    v_xor_b32 v6, v6, v4
    v_lshl_add_u32 v11, v6, 4, v3

    v_add_u32 v6, 4, v5
    v_xor_b32 v6, v6, v4
    v_lshl_add_u32 v12, v6, 4, v3

    v_add_u32 v6, 6, v5
    v_xor_b32 v6, v6, v4
    v_lshl_add_u32 v13, v6, 4, v3

    v_add_u32 v6, 8, v5
    v_xor_b32 v6, v6, v4
    v_lshl_add_u32 v14, v6, 4, v3

    v_add_u32 v6, 10, v5
    v_xor_b32 v6, v6, v4
    v_lshl_add_u32 v15, v6, 4, v3

    v_add_u32 v6, 12, v5
    v_xor_b32 v6, v6, v4
    v_lshl_add_u32 v16, v6, 4, v3

    v_add_u32 v6, 14, v5
    v_xor_b32 v6, v6, v4
    v_lshl_add_u32 v17, v6, 4, v3

    v_lshrrev_b32 v3, 5, v2
    v_lshlrev_b32 v3, 3, v3
    v_bfe_u32 v4, v2, 2, 2
    v_add_u32 v3, v3, v4
    v_lshrrev_b32 v4, 1, v3
    v_and_b32 v4, 1, v4
    v_lshlrev_b32 v4, 2, v4
    v_lshlrev_b32 v3, 7, v3
    v_add_u32 v3, 0x4000, v3
    v_bfe_u32 v5, v2, 4, 1
    v_lshlrev_b32 v5, 1, v5
    v_bfe_u32 v6, v2, 1, 1
    v_add_u32 v5, v5, v6
    s_lshl_b32 s49, s50, 2
    v_add_u32 v5, s49, v5
    v_xor_b32 v5, v5, v4
    v_and_b32 v7, 1, v2
    v_lshlrev_b32 v7, 3, v7
    v_lshl_add_u32 v5, v5, 4, v7
    v_add_u32 v18, v3, v5
    v_add_u32 v56, 0x10000, v18

    v_add_u32 v48, 0x10000, v10
    v_add_u32 v49, 0x10000, v11
    v_add_u32 v50, 0x10000, v12
    v_add_u32 v51, 0x10000, v13
    v_add_u32 v52, 0x10000, v14
    v_add_u32 v53, 0x10000, v15
    v_add_u32 v54, 0x10000, v16
    v_add_u32 v55, 0x10000, v17
    s_add_u32 s8, s4, 60817408
    s_addc_u32 s9, s5, 0
    s_mov_b32 s10, 16777216
    s_mov_b32 s11, 0x20000
    s_mov_b32 s40, 8192
    s_mov_b32 s12, s6
    s_mov_b32 s13, s7
    s_mov_b32 s14, 3670016
    s_mov_b32 s15, 0x20000

    s_lshl_b32 s48, s24, 2
    s_add_u32 s48, s48, 0
    v_lshrrev_b32 v3, 4, v2
    s_lshl_b32 s49, s48, 2
    v_add_u32 v3, s49, v3
    v_and_b32 v4, 15, v3
    v_and_b32 v5, 15, v2
    v_xor_b32 v4, v4, v5
    v_add_u32 v3, s46, v3
    v_mul_lo_u32 v3, v3, s40
    v_lshl_add_u32 v24, v4, 4, v3
    v_lshrrev_b32 v3, 3, v2
    s_lshl_b32 s49, s48, 3
    v_add_u32 v3, s49, v3
    v_lshrrev_b32 v4, 1, v3
    v_and_b32 v4, 1, v4
    v_lshlrev_b32 v4, 2, v4
    v_and_b32 v5, 7, v2
    v_xor_b32 v4, v4, v5
    s_movk_i32 s49, 896
    v_mul_lo_u32 v3, v3, s49
    v_lshl_add_u32 v3, v4, 4, v3
    s_lshl_b32 s49, s47, 1
    v_add_u32 v28, s49, v3

    s_lshl_b32 s48, s24, 2
    s_add_u32 s48, s48, 1
    v_lshrrev_b32 v3, 4, v2
    s_lshl_b32 s49, s48, 2
    v_add_u32 v3, s49, v3
    v_and_b32 v4, 15, v3
    v_and_b32 v5, 15, v2
    v_xor_b32 v4, v4, v5
    v_add_u32 v3, s46, v3
    v_mul_lo_u32 v3, v3, s40
    v_lshl_add_u32 v25, v4, 4, v3
    v_lshrrev_b32 v3, 3, v2
    s_lshl_b32 s49, s48, 3
    v_add_u32 v3, s49, v3
    v_lshrrev_b32 v4, 1, v3
    v_and_b32 v4, 1, v4
    v_lshlrev_b32 v4, 2, v4
    v_and_b32 v5, 7, v2
    v_xor_b32 v4, v4, v5
    s_movk_i32 s49, 896
    v_mul_lo_u32 v3, v3, s49
    v_lshl_add_u32 v3, v4, 4, v3
    s_lshl_b32 s49, s47, 1
    v_add_u32 v29, s49, v3

    s_lshl_b32 s48, s24, 2
    s_add_u32 s48, s48, 2
    v_lshrrev_b32 v3, 4, v2
    s_lshl_b32 s49, s48, 2
    v_add_u32 v3, s49, v3
    v_and_b32 v4, 15, v3
    v_and_b32 v5, 15, v2
    v_xor_b32 v4, v4, v5
    v_add_u32 v3, s46, v3
    v_mul_lo_u32 v3, v3, s40
    v_lshl_add_u32 v26, v4, 4, v3
    v_lshrrev_b32 v3, 3, v2
    s_lshl_b32 s49, s48, 3
    v_add_u32 v3, s49, v3
    v_lshrrev_b32 v4, 1, v3
    v_and_b32 v4, 1, v4
    v_lshlrev_b32 v4, 2, v4
    v_and_b32 v5, 7, v2
    v_xor_b32 v4, v4, v5
    s_movk_i32 s49, 896
    v_mul_lo_u32 v3, v3, s49
    v_lshl_add_u32 v3, v4, 4, v3
    s_lshl_b32 s49, s47, 1
    v_add_u32 v30, s49, v3

    s_lshl_b32 s48, s24, 2
    s_add_u32 s48, s48, 3
    v_lshrrev_b32 v3, 4, v2
    s_lshl_b32 s49, s48, 2
    v_add_u32 v3, s49, v3
    v_and_b32 v4, 15, v3
    v_and_b32 v5, 15, v2
    v_xor_b32 v4, v4, v5
    v_add_u32 v3, s46, v3
    v_mul_lo_u32 v3, v3, s40
    v_lshl_add_u32 v27, v4, 4, v3
    v_lshrrev_b32 v3, 3, v2
    s_lshl_b32 s49, s48, 3
    v_add_u32 v3, s49, v3
    v_lshrrev_b32 v4, 1, v3
    v_and_b32 v4, 1, v4
    v_lshlrev_b32 v4, 2, v4
    v_and_b32 v5, 7, v2
    v_xor_b32 v4, v4, v5
    s_movk_i32 s49, 896
    v_mul_lo_u32 v3, v3, s49
    v_lshl_add_u32 v3, v4, 4, v3
    s_lshl_b32 s49, s47, 1
    v_add_u32 v31, s49, v3

    s_mov_b32 s20, 0
    s_mov_b32 s21, 0
    s_mov_b32 s22, 0

    s_barrier
    s_add_u32 m0, s25, 0
    s_nop 0
    buffer_load_dwordx4 v24, s[8:11], s20 offen lds
    s_add_u32 m0, s25, 1024
    s_nop 0
    buffer_load_dwordx4 v25, s[8:11], s20 offen lds
    s_add_u32 m0, s25, 2048
    s_nop 0
    buffer_load_dwordx4 v26, s[8:11], s20 offen lds
    s_add_u32 m0, s25, 3072
    s_nop 0
    buffer_load_dwordx4 v27, s[8:11], s20 offen lds
    s_add_u32 m0, s25, 16384
    s_nop 0
    buffer_load_dwordx4 v28, s[12:15], s21 offen lds
    s_add_u32 m0, s25, 17408
    s_nop 0
    buffer_load_dwordx4 v29, s[12:15], s21 offen lds
    s_add_u32 m0, s25, 18432
    s_nop 0
    buffer_load_dwordx4 v30, s[12:15], s21 offen lds
    s_add_u32 m0, s25, 19456
    s_nop 0
    buffer_load_dwordx4 v31, s[12:15], s21 offen lds
    s_add_u32 s20, s20, 256
    s_add_u32 s21, s21, 114688
    s_add_u32 m0, s25, 32768
    s_nop 0
    buffer_load_dwordx4 v24, s[8:11], s20 offen lds
    s_add_u32 m0, s25, 33792
    s_nop 0
    buffer_load_dwordx4 v25, s[8:11], s20 offen lds
    s_add_u32 m0, s25, 34816
    s_nop 0
    buffer_load_dwordx4 v26, s[8:11], s20 offen lds
    s_add_u32 m0, s25, 35840
    s_nop 0
    buffer_load_dwordx4 v27, s[8:11], s20 offen lds
    s_add_u32 m0, s25, 49152
    s_nop 0
    buffer_load_dwordx4 v28, s[12:15], s21 offen lds
    s_add_u32 m0, s25, 50176
    s_nop 0
    buffer_load_dwordx4 v29, s[12:15], s21 offen lds
    s_add_u32 m0, s25, 51200
    s_nop 0
    buffer_load_dwordx4 v30, s[12:15], s21 offen lds
    s_add_u32 m0, s25, 52224
    s_nop 0
    buffer_load_dwordx4 v31, s[12:15], s21 offen lds
    s_add_u32 s20, s20, 256
    s_add_u32 s21, s21, 114688
ok_loop0:
    s_waitcnt vmcnt(8)
    s_barrier
    s_add_u32 s22, s22, 1
    s_add_u32 s23, s22, 1
    s_cmp_ge_u32 s23, 32
    s_cbranch_scc1 ok_nd_1_w
    s_add_u32 m0, s25, 65536
    s_nop 0
    buffer_load_dwordx4 v24, s[8:11], s20 offen lds
    s_add_u32 m0, s25, 66560
    s_nop 0
    buffer_load_dwordx4 v25, s[8:11], s20 offen lds
    s_add_u32 m0, s25, 67584
    s_nop 0
    buffer_load_dwordx4 v26, s[8:11], s20 offen lds
    s_add_u32 m0, s25, 68608
    s_nop 0
    buffer_load_dwordx4 v27, s[8:11], s20 offen lds
    s_add_u32 m0, s25, 81920
    s_nop 0
    buffer_load_dwordx4 v28, s[12:15], s21 offen lds
    s_add_u32 m0, s25, 82944
    s_nop 0
    buffer_load_dwordx4 v29, s[12:15], s21 offen lds
    s_add_u32 m0, s25, 83968
    s_nop 0
    buffer_load_dwordx4 v30, s[12:15], s21 offen lds
    s_add_u32 m0, s25, 84992
    s_nop 0
    buffer_load_dwordx4 v31, s[12:15], s21 offen lds
    s_add_u32 s20, s20, 256
    s_add_u32 s21, s21, 114688
    s_branch ok_nd_1
ok_nd_1_w:
    s_waitcnt vmcnt(0)
ok_nd_1:
    ds_read_b64_tr_b16 v[32:33], v18 offset:0
    ds_read_b64_tr_b16 v[34:35], v18 offset:512
    ds_read_b128 v[36:39], v10 offset:0
    ds_read_b64_tr_b16 v[40:41], v18 offset:2048
    ds_read_b64_tr_b16 v[42:43], v18 offset:2560
    ds_read_b128 v[44:47], v11 offset:0
    s_waitcnt lgkmcnt(3)
    v_mfma_f32_32x32x16_bf16 v[64:79], v[32:35], v[36:39], v[64:79]
    ds_read_b64_tr_b16 v[32:33], v18 offset:4096
    ds_read_b64_tr_b16 v[34:35], v18 offset:4608
    ds_read_b128 v[36:39], v12 offset:0
    s_waitcnt lgkmcnt(3)
    v_mfma_f32_32x32x16_bf16 v[64:79], v[40:43], v[44:47], v[64:79]
    ds_read_b64_tr_b16 v[40:41], v18 offset:6144
    ds_read_b64_tr_b16 v[42:43], v18 offset:6656
    ds_read_b128 v[44:47], v13 offset:0
    s_waitcnt lgkmcnt(3)
    v_mfma_f32_32x32x16_bf16 v[64:79], v[32:35], v[36:39], v[64:79]
    ds_read_b64_tr_b16 v[32:33], v18 offset:8192
    ds_read_b64_tr_b16 v[34:35], v18 offset:8704
    ds_read_b128 v[36:39], v14 offset:0
    s_waitcnt lgkmcnt(3)
    v_mfma_f32_32x32x16_bf16 v[64:79], v[40:43], v[44:47], v[64:79]
    ds_read_b64_tr_b16 v[40:41], v18 offset:10240
    ds_read_b64_tr_b16 v[42:43], v18 offset:10752
    ds_read_b128 v[44:47], v15 offset:0
    s_waitcnt lgkmcnt(3)
    v_mfma_f32_32x32x16_bf16 v[64:79], v[32:35], v[36:39], v[64:79]
    ds_read_b64_tr_b16 v[32:33], v18 offset:12288
    ds_read_b64_tr_b16 v[34:35], v18 offset:12800
    ds_read_b128 v[36:39], v16 offset:0
    s_waitcnt lgkmcnt(3)
    v_mfma_f32_32x32x16_bf16 v[64:79], v[40:43], v[44:47], v[64:79]
    ds_read_b64_tr_b16 v[40:41], v18 offset:14336
    ds_read_b64_tr_b16 v[42:43], v18 offset:14848
    ds_read_b128 v[44:47], v17 offset:0
    s_waitcnt lgkmcnt(3)
    v_mfma_f32_32x32x16_bf16 v[64:79], v[32:35], v[36:39], v[64:79]
    s_waitcnt lgkmcnt(0)
    v_mfma_f32_32x32x16_bf16 v[64:79], v[40:43], v[44:47], v[64:79]
    s_cmp_ge_u32 s22, 32
    s_cbranch_scc1 ok_end0
    s_waitcnt vmcnt(8)
    s_barrier
    s_add_u32 s22, s22, 1
    s_add_u32 s23, s22, 1
    s_cmp_ge_u32 s23, 32
    s_cbranch_scc1 ok_nd_2_w
    s_add_u32 m0, s25, 0
    s_nop 0
    buffer_load_dwordx4 v24, s[8:11], s20 offen lds
    s_add_u32 m0, s25, 1024
    s_nop 0
    buffer_load_dwordx4 v25, s[8:11], s20 offen lds
    s_add_u32 m0, s25, 2048
    s_nop 0
    buffer_load_dwordx4 v26, s[8:11], s20 offen lds
    s_add_u32 m0, s25, 3072
    s_nop 0
    buffer_load_dwordx4 v27, s[8:11], s20 offen lds
    s_add_u32 m0, s25, 16384
    s_nop 0
    buffer_load_dwordx4 v28, s[12:15], s21 offen lds
    s_add_u32 m0, s25, 17408
    s_nop 0
    buffer_load_dwordx4 v29, s[12:15], s21 offen lds
    s_add_u32 m0, s25, 18432
    s_nop 0
    buffer_load_dwordx4 v30, s[12:15], s21 offen lds
    s_add_u32 m0, s25, 19456
    s_nop 0
    buffer_load_dwordx4 v31, s[12:15], s21 offen lds
    s_add_u32 s20, s20, 256
    s_add_u32 s21, s21, 114688
    s_branch ok_nd_2
ok_nd_2_w:
    s_waitcnt vmcnt(0)
ok_nd_2:
    ds_read_b64_tr_b16 v[32:33], v18 offset:32768
    ds_read_b64_tr_b16 v[34:35], v18 offset:33280
    ds_read_b128 v[36:39], v10 offset:32768
    ds_read_b64_tr_b16 v[40:41], v18 offset:34816
    ds_read_b64_tr_b16 v[42:43], v18 offset:35328
    ds_read_b128 v[44:47], v11 offset:32768
    s_waitcnt lgkmcnt(3)
    v_mfma_f32_32x32x16_bf16 v[64:79], v[32:35], v[36:39], v[64:79]
    ds_read_b64_tr_b16 v[32:33], v18 offset:36864
    ds_read_b64_tr_b16 v[34:35], v18 offset:37376
    ds_read_b128 v[36:39], v12 offset:32768
    s_waitcnt lgkmcnt(3)
    v_mfma_f32_32x32x16_bf16 v[64:79], v[40:43], v[44:47], v[64:79]
    ds_read_b64_tr_b16 v[40:41], v18 offset:38912
    ds_read_b64_tr_b16 v[42:43], v18 offset:39424
    ds_read_b128 v[44:47], v13 offset:32768
    s_waitcnt lgkmcnt(3)
    v_mfma_f32_32x32x16_bf16 v[64:79], v[32:35], v[36:39], v[64:79]
    ds_read_b64_tr_b16 v[32:33], v18 offset:40960
    ds_read_b64_tr_b16 v[34:35], v18 offset:41472
    ds_read_b128 v[36:39], v14 offset:32768
    s_waitcnt lgkmcnt(3)
    v_mfma_f32_32x32x16_bf16 v[64:79], v[40:43], v[44:47], v[64:79]
    ds_read_b64_tr_b16 v[40:41], v18 offset:43008
    ds_read_b64_tr_b16 v[42:43], v18 offset:43520
    ds_read_b128 v[44:47], v15 offset:32768
    s_waitcnt lgkmcnt(3)
    v_mfma_f32_32x32x16_bf16 v[64:79], v[32:35], v[36:39], v[64:79]
    ds_read_b64_tr_b16 v[32:33], v18 offset:45056
    ds_read_b64_tr_b16 v[34:35], v18 offset:45568
    ds_read_b128 v[36:39], v16 offset:32768
    s_waitcnt lgkmcnt(3)
    v_mfma_f32_32x32x16_bf16 v[64:79], v[40:43], v[44:47], v[64:79]
    ds_read_b64_tr_b16 v[40:41], v18 offset:47104
    ds_read_b64_tr_b16 v[42:43], v18 offset:47616
    ds_read_b128 v[44:47], v17 offset:32768
    s_waitcnt lgkmcnt(3)
    v_mfma_f32_32x32x16_bf16 v[64:79], v[32:35], v[36:39], v[64:79]
    s_waitcnt lgkmcnt(0)
    v_mfma_f32_32x32x16_bf16 v[64:79], v[40:43], v[44:47], v[64:79]
    s_cmp_ge_u32 s22, 32
    s_cbranch_scc1 ok_end0
    s_waitcnt vmcnt(8)
    s_barrier
    s_add_u32 s22, s22, 1
    s_add_u32 s23, s22, 1
    s_cmp_ge_u32 s23, 32
    s_cbranch_scc1 ok_nd_3_w
    s_add_u32 m0, s25, 32768
    s_nop 0
    buffer_load_dwordx4 v24, s[8:11], s20 offen lds
    s_add_u32 m0, s25, 33792
    s_nop 0
    buffer_load_dwordx4 v25, s[8:11], s20 offen lds
    s_add_u32 m0, s25, 34816
    s_nop 0
    buffer_load_dwordx4 v26, s[8:11], s20 offen lds
    s_add_u32 m0, s25, 35840
    s_nop 0
    buffer_load_dwordx4 v27, s[8:11], s20 offen lds
    s_add_u32 m0, s25, 49152
    s_nop 0
    buffer_load_dwordx4 v28, s[12:15], s21 offen lds
    s_add_u32 m0, s25, 50176
    s_nop 0
    buffer_load_dwordx4 v29, s[12:15], s21 offen lds
    s_add_u32 m0, s25, 51200
    s_nop 0
    buffer_load_dwordx4 v30, s[12:15], s21 offen lds
    s_add_u32 m0, s25, 52224
    s_nop 0
    buffer_load_dwordx4 v31, s[12:15], s21 offen lds
    s_add_u32 s20, s20, 256
    s_add_u32 s21, s21, 114688
    s_branch ok_nd_3
ok_nd_3_w:
    s_waitcnt vmcnt(0)
ok_nd_3:
    ds_read_b64_tr_b16 v[32:33], v56 offset:0
    ds_read_b64_tr_b16 v[34:35], v56 offset:512
    ds_read_b128 v[36:39], v48 offset:0
    ds_read_b64_tr_b16 v[40:41], v56 offset:2048
    ds_read_b64_tr_b16 v[42:43], v56 offset:2560
    ds_read_b128 v[44:47], v49 offset:0
    s_waitcnt lgkmcnt(3)
    v_mfma_f32_32x32x16_bf16 v[64:79], v[32:35], v[36:39], v[64:79]
    ds_read_b64_tr_b16 v[32:33], v56 offset:4096
    ds_read_b64_tr_b16 v[34:35], v56 offset:4608
    ds_read_b128 v[36:39], v50 offset:0
    s_waitcnt lgkmcnt(3)
    v_mfma_f32_32x32x16_bf16 v[64:79], v[40:43], v[44:47], v[64:79]
    ds_read_b64_tr_b16 v[40:41], v56 offset:6144
    ds_read_b64_tr_b16 v[42:43], v56 offset:6656
    ds_read_b128 v[44:47], v51 offset:0
    s_waitcnt lgkmcnt(3)
    v_mfma_f32_32x32x16_bf16 v[64:79], v[32:35], v[36:39], v[64:79]
    ds_read_b64_tr_b16 v[32:33], v56 offset:8192
    ds_read_b64_tr_b16 v[34:35], v56 offset:8704
    ds_read_b128 v[36:39], v52 offset:0
    s_waitcnt lgkmcnt(3)
    v_mfma_f32_32x32x16_bf16 v[64:79], v[40:43], v[44:47], v[64:79]
    ds_read_b64_tr_b16 v[40:41], v56 offset:10240
    ds_read_b64_tr_b16 v[42:43], v56 offset:10752
    ds_read_b128 v[44:47], v53 offset:0
    s_waitcnt lgkmcnt(3)
    v_mfma_f32_32x32x16_bf16 v[64:79], v[32:35], v[36:39], v[64:79]
    ds_read_b64_tr_b16 v[32:33], v56 offset:12288
    ds_read_b64_tr_b16 v[34:35], v56 offset:12800
    ds_read_b128 v[36:39], v54 offset:0
    s_waitcnt lgkmcnt(3)
    v_mfma_f32_32x32x16_bf16 v[64:79], v[40:43], v[44:47], v[64:79]
    ds_read_b64_tr_b16 v[40:41], v56 offset:14336
    ds_read_b64_tr_b16 v[42:43], v56 offset:14848
    ds_read_b128 v[44:47], v55 offset:0
    s_waitcnt lgkmcnt(3)
    v_mfma_f32_32x32x16_bf16 v[64:79], v[32:35], v[36:39], v[64:79]
    s_waitcnt lgkmcnt(0)
    v_mfma_f32_32x32x16_bf16 v[64:79], v[40:43], v[44:47], v[64:79]
    s_cmp_ge_u32 s22, 32
    s_cbranch_scc0 ok_loop0
ok_end0:
    s_add_u32 s8, s4, 52428800
    s_addc_u32 s9, s5, 0
    s_mov_b32 s10, 7340032
    s_mov_b32 s40, 3584
    s_mov_b32 s12, s26
    s_mov_b32 s13, s27
    s_mov_b32 s14, 1605632

    s_lshl_b32 s48, s24, 2
    s_add_u32 s48, s48, 0
    v_lshrrev_b32 v3, 4, v2
    s_lshl_b32 s49, s48, 2
    v_add_u32 v3, s49, v3
    v_and_b32 v4, 15, v3
    v_and_b32 v5, 15, v2
    v_xor_b32 v4, v4, v5
    v_add_u32 v3, s46, v3
    v_mul_lo_u32 v3, v3, s40
    v_lshl_add_u32 v24, v4, 4, v3
    v_lshrrev_b32 v3, 3, v2
    s_lshl_b32 s49, s48, 3
    v_add_u32 v3, s49, v3
    v_lshrrev_b32 v4, 1, v3
    v_and_b32 v4, 1, v4
    v_lshlrev_b32 v4, 2, v4
    v_and_b32 v5, 7, v2
    v_xor_b32 v4, v4, v5
    s_movk_i32 s49, 896
    v_mul_lo_u32 v3, v3, s49
    v_lshl_add_u32 v3, v4, 4, v3
    s_lshl_b32 s49, s47, 1
    v_add_u32 v28, s49, v3

    s_lshl_b32 s48, s24, 2
    s_add_u32 s48, s48, 1
    v_lshrrev_b32 v3, 4, v2
    s_lshl_b32 s49, s48, 2
    v_add_u32 v3, s49, v3
    v_and_b32 v4, 15, v3
    v_and_b32 v5, 15, v2
    v_xor_b32 v4, v4, v5
    v_add_u32 v3, s46, v3
    v_mul_lo_u32 v3, v3, s40
    v_lshl_add_u32 v25, v4, 4, v3
    v_lshrrev_b32 v3, 3, v2
    s_lshl_b32 s49, s48, 3
    v_add_u32 v3, s49, v3
    v_lshrrev_b32 v4, 1, v3
    v_and_b32 v4, 1, v4
    v_lshlrev_b32 v4, 2, v4
    v_and_b32 v5, 7, v2
    v_xor_b32 v4, v4, v5
    s_movk_i32 s49, 896
    v_mul_lo_u32 v3, v3, s49
    v_lshl_add_u32 v3, v4, 4, v3
    s_lshl_b32 s49, s47, 1
    v_add_u32 v29, s49, v3

    s_lshl_b32 s48, s24, 2
    s_add_u32 s48, s48, 2
    v_lshrrev_b32 v3, 4, v2
    s_lshl_b32 s49, s48, 2
    v_add_u32 v3, s49, v3
    v_and_b32 v4, 15, v3
    v_and_b32 v5, 15, v2
    v_xor_b32 v4, v4, v5
    v_add_u32 v3, s46, v3
    v_mul_lo_u32 v3, v3, s40
    v_lshl_add_u32 v26, v4, 4, v3
    v_lshrrev_b32 v3, 3, v2
    s_lshl_b32 s49, s48, 3
    v_add_u32 v3, s49, v3
    v_lshrrev_b32 v4, 1, v3
    v_and_b32 v4, 1, v4
    v_lshlrev_b32 v4, 2, v4
    v_and_b32 v5, 7, v2
    v_xor_b32 v4, v4, v5
    s_movk_i32 s49, 896
    v_mul_lo_u32 v3, v3, s49
    v_lshl_add_u32 v3, v4, 4, v3
    s_lshl_b32 s49, s47, 1
    v_add_u32 v30, s49, v3

    s_lshl_b32 s48, s24, 2
    s_add_u32 s48, s48, 3
    v_lshrrev_b32 v3, 4, v2
    s_lshl_b32 s49, s48, 2
    v_add_u32 v3, s49, v3
    v_and_b32 v4, 15, v3
    v_and_b32 v5, 15, v2
    v_xor_b32 v4, v4, v5
    v_add_u32 v3, s46, v3
    v_mul_lo_u32 v3, v3, s40
    v_lshl_add_u32 v27, v4, 4, v3
    v_lshrrev_b32 v3, 3, v2
    s_lshl_b32 s49, s48, 3
    v_add_u32 v3, s49, v3
    v_lshrrev_b32 v4, 1, v3
    v_and_b32 v4, 1, v4
    v_lshlrev_b32 v4, 2, v4
    v_and_b32 v5, 7, v2
    v_xor_b32 v4, v4, v5
    s_movk_i32 s49, 896
    v_mul_lo_u32 v3, v3, s49
    v_lshl_add_u32 v3, v4, 4, v3
    s_lshl_b32 s49, s47, 1
    v_add_u32 v31, s49, v3

    s_mov_b32 s20, 0
    s_mov_b32 s21, 0
    s_mov_b32 s22, 0

    s_barrier
    s_add_u32 m0, s25, 0
    s_nop 0
    buffer_load_dwordx4 v24, s[8:11], s20 offen lds
    s_add_u32 m0, s25, 1024
    s_nop 0
    buffer_load_dwordx4 v25, s[8:11], s20 offen lds
    s_add_u32 m0, s25, 2048
    s_nop 0
    buffer_load_dwordx4 v26, s[8:11], s20 offen lds
    s_add_u32 m0, s25, 3072
    s_nop 0
    buffer_load_dwordx4 v27, s[8:11], s20 offen lds
    s_add_u32 m0, s25, 16384
    s_nop 0
    buffer_load_dwordx4 v28, s[12:15], s21 offen lds
    s_add_u32 m0, s25, 17408
    s_nop 0
    buffer_load_dwordx4 v29, s[12:15], s21 offen lds
    s_add_u32 m0, s25, 18432
    s_nop 0
    buffer_load_dwordx4 v30, s[12:15], s21 offen lds
    s_add_u32 m0, s25, 19456
    s_nop 0
    buffer_load_dwordx4 v31, s[12:15], s21 offen lds
    s_add_u32 s20, s20, 256
    s_add_u32 s21, s21, 114688
    s_add_u32 m0, s25, 32768
    s_nop 0
    buffer_load_dwordx4 v24, s[8:11], s20 offen lds
    s_add_u32 m0, s25, 33792
    s_nop 0
    buffer_load_dwordx4 v25, s[8:11], s20 offen lds
    s_add_u32 m0, s25, 34816
    s_nop 0
    buffer_load_dwordx4 v26, s[8:11], s20 offen lds
    s_add_u32 m0, s25, 35840
    s_nop 0
    buffer_load_dwordx4 v27, s[8:11], s20 offen lds
    s_add_u32 m0, s25, 49152
    s_nop 0
    buffer_load_dwordx4 v28, s[12:15], s21 offen lds
    s_add_u32 m0, s25, 50176
    s_nop 0
    buffer_load_dwordx4 v29, s[12:15], s21 offen lds
    s_add_u32 m0, s25, 51200
    s_nop 0
    buffer_load_dwordx4 v30, s[12:15], s21 offen lds
    s_add_u32 m0, s25, 52224
    s_nop 0
    buffer_load_dwordx4 v31, s[12:15], s21 offen lds
    s_add_u32 s20, s20, 256
    s_add_u32 s21, s21, 114688
ok_loop1:
    s_waitcnt vmcnt(8)
    s_barrier
    s_add_u32 s22, s22, 1
    s_add_u32 s23, s22, 1
    s_cmp_ge_u32 s23, 14
    s_cbranch_scc1 ok_nd_4_w
    s_add_u32 m0, s25, 65536
    s_nop 0
    buffer_load_dwordx4 v24, s[8:11], s20 offen lds
    s_add_u32 m0, s25, 66560
    s_nop 0
    buffer_load_dwordx4 v25, s[8:11], s20 offen lds
    s_add_u32 m0, s25, 67584
    s_nop 0
    buffer_load_dwordx4 v26, s[8:11], s20 offen lds
    s_add_u32 m0, s25, 68608
    s_nop 0
    buffer_load_dwordx4 v27, s[8:11], s20 offen lds
    s_add_u32 m0, s25, 81920
    s_nop 0
    buffer_load_dwordx4 v28, s[12:15], s21 offen lds
    s_add_u32 m0, s25, 82944
    s_nop 0
    buffer_load_dwordx4 v29, s[12:15], s21 offen lds
    s_add_u32 m0, s25, 83968
    s_nop 0
    buffer_load_dwordx4 v30, s[12:15], s21 offen lds
    s_add_u32 m0, s25, 84992
    s_nop 0
    buffer_load_dwordx4 v31, s[12:15], s21 offen lds
    s_add_u32 s20, s20, 256
    s_add_u32 s21, s21, 114688
    s_branch ok_nd_4
ok_nd_4_w:
    s_waitcnt vmcnt(0)
ok_nd_4:
    ds_read_b64_tr_b16 v[32:33], v18 offset:0
    ds_read_b64_tr_b16 v[34:35], v18 offset:512
    ds_read_b128 v[36:39], v10 offset:0
    ds_read_b64_tr_b16 v[40:41], v18 offset:2048
    ds_read_b64_tr_b16 v[42:43], v18 offset:2560
    ds_read_b128 v[44:47], v11 offset:0
    s_waitcnt lgkmcnt(3)
    v_mfma_f32_32x32x16_bf16 v[80:95], v[32:35], v[36:39], v[80:95]
    ds_read_b64_tr_b16 v[32:33], v18 offset:4096
    ds_read_b64_tr_b16 v[34:35], v18 offset:4608
    ds_read_b128 v[36:39], v12 offset:0
    s_waitcnt lgkmcnt(3)
    v_mfma_f32_32x32x16_bf16 v[80:95], v[40:43], v[44:47], v[80:95]
    ds_read_b64_tr_b16 v[40:41], v18 offset:6144
    ds_read_b64_tr_b16 v[42:43], v18 offset:6656
    ds_read_b128 v[44:47], v13 offset:0
    s_waitcnt lgkmcnt(3)
    v_mfma_f32_32x32x16_bf16 v[80:95], v[32:35], v[36:39], v[80:95]
    ds_read_b64_tr_b16 v[32:33], v18 offset:8192
    ds_read_b64_tr_b16 v[34:35], v18 offset:8704
    ds_read_b128 v[36:39], v14 offset:0
    s_waitcnt lgkmcnt(3)
    v_mfma_f32_32x32x16_bf16 v[80:95], v[40:43], v[44:47], v[80:95]
    ds_read_b64_tr_b16 v[40:41], v18 offset:10240
    ds_read_b64_tr_b16 v[42:43], v18 offset:10752
    ds_read_b128 v[44:47], v15 offset:0
    s_waitcnt lgkmcnt(3)
    v_mfma_f32_32x32x16_bf16 v[80:95], v[32:35], v[36:39], v[80:95]
    ds_read_b64_tr_b16 v[32:33], v18 offset:12288
    ds_read_b64_tr_b16 v[34:35], v18 offset:12800
    ds_read_b128 v[36:39], v16 offset:0
    s_waitcnt lgkmcnt(3)
    v_mfma_f32_32x32x16_bf16 v[80:95], v[40:43], v[44:47], v[80:95]
    ds_read_b64_tr_b16 v[40:41], v18 offset:14336
    ds_read_b64_tr_b16 v[42:43], v18 offset:14848
    ds_read_b128 v[44:47], v17 offset:0
    s_waitcnt lgkmcnt(3)
    v_mfma_f32_32x32x16_bf16 v[80:95], v[32:35], v[36:39], v[80:95]
    s_waitcnt lgkmcnt(0)
    v_mfma_f32_32x32x16_bf16 v[80:95], v[40:43], v[44:47], v[80:95]
    s_cmp_ge_u32 s22, 14
    s_cbranch_scc1 ok_end1
    s_waitcnt vmcnt(8)
    s_barrier
    s_add_u32 s22, s22, 1
    s_add_u32 s23, s22, 1
    s_cmp_ge_u32 s23, 14
    s_cbranch_scc1 ok_nd_5_w
    s_add_u32 m0, s25, 0
    s_nop 0
    buffer_load_dwordx4 v24, s[8:11], s20 offen lds
    s_add_u32 m0, s25, 1024
    s_nop 0
    buffer_load_dwordx4 v25, s[8:11], s20 offen lds
    s_add_u32 m0, s25, 2048
    s_nop 0
    buffer_load_dwordx4 v26, s[8:11], s20 offen lds
    s_add_u32 m0, s25, 3072
    s_nop 0
    buffer_load_dwordx4 v27, s[8:11], s20 offen lds
    s_add_u32 m0, s25, 16384
    s_nop 0
    buffer_load_dwordx4 v28, s[12:15], s21 offen lds
    s_add_u32 m0, s25, 17408
    s_nop 0
    buffer_load_dwordx4 v29, s[12:15], s21 offen lds
    s_add_u32 m0, s25, 18432
    s_nop 0
    buffer_load_dwordx4 v30, s[12:15], s21 offen lds
    s_add_u32 m0, s25, 19456
    s_nop 0
    buffer_load_dwordx4 v31, s[12:15], s21 offen lds
    s_add_u32 s20, s20, 256
    s_add_u32 s21, s21, 114688
    s_branch ok_nd_5
ok_nd_5_w:
    s_waitcnt vmcnt(0)
ok_nd_5:
    ds_read_b64_tr_b16 v[32:33], v18 offset:32768
    ds_read_b64_tr_b16 v[34:35], v18 offset:33280
    ds_read_b128 v[36:39], v10 offset:32768
    ds_read_b64_tr_b16 v[40:41], v18 offset:34816
    ds_read_b64_tr_b16 v[42:43], v18 offset:35328
    ds_read_b128 v[44:47], v11 offset:32768
    s_waitcnt lgkmcnt(3)
    v_mfma_f32_32x32x16_bf16 v[80:95], v[32:35], v[36:39], v[80:95]
    ds_read_b64_tr_b16 v[32:33], v18 offset:36864
    ds_read_b64_tr_b16 v[34:35], v18 offset:37376
    ds_read_b128 v[36:39], v12 offset:32768
    s_waitcnt lgkmcnt(3)
    v_mfma_f32_32x32x16_bf16 v[80:95], v[40:43], v[44:47], v[80:95]
    ds_read_b64_tr_b16 v[40:41], v18 offset:38912
    ds_read_b64_tr_b16 v[42:43], v18 offset:39424
    ds_read_b128 v[44:47], v13 offset:32768
    s_waitcnt lgkmcnt(3)
    v_mfma_f32_32x32x16_bf16 v[80:95], v[32:35], v[36:39], v[80:95]
    ds_read_b64_tr_b16 v[32:33], v18 offset:40960
    ds_read_b64_tr_b16 v[34:35], v18 offset:41472
    ds_read_b128 v[36:39], v14 offset:32768
    s_waitcnt lgkmcnt(3)
    v_mfma_f32_32x32x16_bf16 v[80:95], v[40:43], v[44:47], v[80:95]
    ds_read_b64_tr_b16 v[40:41], v18 offset:43008
    ds_read_b64_tr_b16 v[42:43], v18 offset:43520
    ds_read_b128 v[44:47], v15 offset:32768
    s_waitcnt lgkmcnt(3)
    v_mfma_f32_32x32x16_bf16 v[80:95], v[32:35], v[36:39], v[80:95]
    ds_read_b64_tr_b16 v[32:33], v18 offset:45056
    ds_read_b64_tr_b16 v[34:35], v18 offset:45568
    ds_read_b128 v[36:39], v16 offset:32768
    s_waitcnt lgkmcnt(3)
    v_mfma_f32_32x32x16_bf16 v[80:95], v[40:43], v[44:47], v[80:95]
    ds_read_b64_tr_b16 v[40:41], v18 offset:47104
    ds_read_b64_tr_b16 v[42:43], v18 offset:47616
    ds_read_b128 v[44:47], v17 offset:32768
    s_waitcnt lgkmcnt(3)
    v_mfma_f32_32x32x16_bf16 v[80:95], v[32:35], v[36:39], v[80:95]
    s_waitcnt lgkmcnt(0)
    v_mfma_f32_32x32x16_bf16 v[80:95], v[40:43], v[44:47], v[80:95]
    s_cmp_ge_u32 s22, 14
    s_cbranch_scc1 ok_end1
    s_waitcnt vmcnt(8)
    s_barrier
    s_add_u32 s22, s22, 1
    s_add_u32 s23, s22, 1
    s_cmp_ge_u32 s23, 14
    s_cbranch_scc1 ok_nd_6_w
    s_add_u32 m0, s25, 32768
    s_nop 0
    buffer_load_dwordx4 v24, s[8:11], s20 offen lds
    s_add_u32 m0, s25, 33792
    s_nop 0
    buffer_load_dwordx4 v25, s[8:11], s20 offen lds
    s_add_u32 m0, s25, 34816
    s_nop 0
    buffer_load_dwordx4 v26, s[8:11], s20 offen lds
    s_add_u32 m0, s25, 35840
    s_nop 0
    buffer_load_dwordx4 v27, s[8:11], s20 offen lds
    s_add_u32 m0, s25, 49152
    s_nop 0
    buffer_load_dwordx4 v28, s[12:15], s21 offen lds
    s_add_u32 m0, s25, 50176
    s_nop 0
    buffer_load_dwordx4 v29, s[12:15], s21 offen lds
    s_add_u32 m0, s25, 51200
    s_nop 0
    buffer_load_dwordx4 v30, s[12:15], s21 offen lds
    s_add_u32 m0, s25, 52224
    s_nop 0
    buffer_load_dwordx4 v31, s[12:15], s21 offen lds
    s_add_u32 s20, s20, 256
    s_add_u32 s21, s21, 114688
    s_branch ok_nd_6
ok_nd_6_w:
    s_waitcnt vmcnt(0)
ok_nd_6:
    ds_read_b64_tr_b16 v[32:33], v56 offset:0
    ds_read_b64_tr_b16 v[34:35], v56 offset:512
    ds_read_b128 v[36:39], v48 offset:0
    ds_read_b64_tr_b16 v[40:41], v56 offset:2048
    ds_read_b64_tr_b16 v[42:43], v56 offset:2560
    ds_read_b128 v[44:47], v49 offset:0
    s_waitcnt lgkmcnt(3)
    v_mfma_f32_32x32x16_bf16 v[80:95], v[32:35], v[36:39], v[80:95]
    ds_read_b64_tr_b16 v[32:33], v56 offset:4096
    ds_read_b64_tr_b16 v[34:35], v56 offset:4608
    ds_read_b128 v[36:39], v50 offset:0
    s_waitcnt lgkmcnt(3)
    v_mfma_f32_32x32x16_bf16 v[80:95], v[40:43], v[44:47], v[80:95]
    ds_read_b64_tr_b16 v[40:41], v56 offset:6144
    ds_read_b64_tr_b16 v[42:43], v56 offset:6656
    ds_read_b128 v[44:47], v51 offset:0
    s_waitcnt lgkmcnt(3)
    v_mfma_f32_32x32x16_bf16 v[80:95], v[32:35], v[36:39], v[80:95]
    ds_read_b64_tr_b16 v[32:33], v56 offset:8192
    ds_read_b64_tr_b16 v[34:35], v56 offset:8704
    ds_read_b128 v[36:39], v52 offset:0
    s_waitcnt lgkmcnt(3)
    v_mfma_f32_32x32x16_bf16 v[80:95], v[40:43], v[44:47], v[80:95]
    ds_read_b64_tr_b16 v[40:41], v56 offset:10240
    ds_read_b64_tr_b16 v[42:43], v56 offset:10752
    ds_read_b128 v[44:47], v53 offset:0
    s_waitcnt lgkmcnt(3)
    v_mfma_f32_32x32x16_bf16 v[80:95], v[32:35], v[36:39], v[80:95]
    ds_read_b64_tr_b16 v[32:33], v56 offset:12288
    ds_read_b64_tr_b16 v[34:35], v56 offset:12800
    ds_read_b128 v[36:39], v54 offset:0
    s_waitcnt lgkmcnt(3)
    v_mfma_f32_32x32x16_bf16 v[80:95], v[40:43], v[44:47], v[80:95]
    ds_read_b64_tr_b16 v[40:41], v56 offset:14336
    ds_read_b64_tr_b16 v[42:43], v56 offset:14848
    ds_read_b128 v[44:47], v55 offset:0
    s_waitcnt lgkmcnt(3)
    v_mfma_f32_32x32x16_bf16 v[80:95], v[32:35], v[36:39], v[80:95]
    s_waitcnt lgkmcnt(0)
    v_mfma_f32_32x32x16_bf16 v[80:95], v[40:43], v[44:47], v[80:95]
    s_cmp_ge_u32 s22, 14
    s_cbranch_scc0 ok_loop1
ok_end1:
    s_mov_b32 s8, s28
    s_mov_b32 s9, s29
    s_mov_b32 s10, 1835008
    s_mov_b32 s11, 0x20000
    s_mov_b32 s12, s30
    s_mov_b32 s13, s31
    s_mov_b32 s14, 1835008
    s_mov_b32 s15, 0x20000
    v_and_b32 v3, 31, v2
    s_lshl_b32 s49, s51, 5
    s_add_u32 s49, s49, s46
    v_add_u32 v3, s49, v3
    s_movk_i32 s49, 896
    v_mul_lo_u32 v3, v3, s49
    v_lshrrev_b32 v4, 5, v2
    v_lshl_add_u32 v3, v4, 3, v3
    s_lshl_b32 s49, s50, 6
    s_lshl_b32 s48, s47, 1
    s_add_u32 s49, s49, s48
    v_add_u32 v3, s49, v3

    buffer_load_dwordx2 v[40:41], v3, s[8:11], 0 offen offset:0
    buffer_load_dwordx2 v[42:43], v3, s[8:11], 0 offen offset:16
    buffer_load_dwordx2 v[44:45], v3, s[8:11], 0 offen offset:32
    buffer_load_dwordx2 v[46:47], v3, s[8:11], 0 offen offset:48
    s_nop 7
    s_nop 7
    s_waitcnt vmcnt(0)
    v_cvt_pk_bf16_f32 v4, v64, v80
    v_lshlrev_b32 v5, 16, v4
    v_and_b32 v6, 0xffff0000, v4
    v_mul_f32 v7, 0xbfb8aa3b, v6
    v_exp_f32 v7, v7
    s_nop 0
    v_add_f32 v7, 1.0, v7
    v_rcp_f32 v7, v7
    s_nop 0
    v_mul_f32 v6, v6, v7
    v_cvt_pk_bf16_f32 v6, v6, v6
    v_lshlrev_b32 v6, 16, v6
    v_mul_f32 v5, v5, v6
    v_cvt_pk_bf16_f32 v5, v5, v5
    v_lshlrev_b32 v5, 16, v5

    v_lshlrev_b32 v6, 16, v40
    v_add_f32 v8, v5, v6
    v_cvt_pk_bf16_f32 v4, v65, v81
    v_lshlrev_b32 v5, 16, v4
    v_and_b32 v6, 0xffff0000, v4
    v_mul_f32 v7, 0xbfb8aa3b, v6
    v_exp_f32 v7, v7
    s_nop 0
    v_add_f32 v7, 1.0, v7
    v_rcp_f32 v7, v7
    s_nop 0
    v_mul_f32 v6, v6, v7
    v_cvt_pk_bf16_f32 v6, v6, v6
    v_lshlrev_b32 v6, 16, v6
    v_mul_f32 v5, v5, v6
    v_cvt_pk_bf16_f32 v5, v5, v5
    v_lshlrev_b32 v5, 16, v5

    v_and_b32 v6, 0xffff0000, v40
    v_add_f32 v9, v5, v6
    v_cvt_pk_bf16_f32 v4, v66, v82
    v_lshlrev_b32 v5, 16, v4
    v_and_b32 v6, 0xffff0000, v4
    v_mul_f32 v7, 0xbfb8aa3b, v6
    v_exp_f32 v7, v7
    s_nop 0
    v_add_f32 v7, 1.0, v7
    v_rcp_f32 v7, v7
    s_nop 0
    v_mul_f32 v6, v6, v7
    v_cvt_pk_bf16_f32 v6, v6, v6
    v_lshlrev_b32 v6, 16, v6
    v_mul_f32 v5, v5, v6
    v_cvt_pk_bf16_f32 v5, v5, v5
    v_lshlrev_b32 v5, 16, v5

    v_lshlrev_b32 v6, 16, v41
    v_add_f32 v10, v5, v6
    v_cvt_pk_bf16_f32 v4, v67, v83
    v_lshlrev_b32 v5, 16, v4
    v_and_b32 v6, 0xffff0000, v4
    v_mul_f32 v7, 0xbfb8aa3b, v6
    v_exp_f32 v7, v7
    s_nop 0
    v_add_f32 v7, 1.0, v7
    v_rcp_f32 v7, v7
    s_nop 0
    v_mul_f32 v6, v6, v7
    v_cvt_pk_bf16_f32 v6, v6, v6
    v_lshlrev_b32 v6, 16, v6
    v_mul_f32 v5, v5, v6
    v_cvt_pk_bf16_f32 v5, v5, v5
    v_lshlrev_b32 v5, 16, v5

    v_and_b32 v6, 0xffff0000, v41
    v_add_f32 v11, v5, v6
    v_cvt_pk_bf16_f32 v20, v8, v9
    v_cvt_pk_bf16_f32 v21, v10, v11
    buffer_store_dwordx2 v[20:21], v3, s[12:15], 0 offen offset:0
    v_cvt_pk_bf16_f32 v4, v68, v84
    v_lshlrev_b32 v5, 16, v4
    v_and_b32 v6, 0xffff0000, v4
    v_mul_f32 v7, 0xbfb8aa3b, v6
    v_exp_f32 v7, v7
    s_nop 0
    v_add_f32 v7, 1.0, v7
    v_rcp_f32 v7, v7
    s_nop 0
    v_mul_f32 v6, v6, v7
    v_cvt_pk_bf16_f32 v6, v6, v6
    v_lshlrev_b32 v6, 16, v6
    v_mul_f32 v5, v5, v6
    v_cvt_pk_bf16_f32 v5, v5, v5
    v_lshlrev_b32 v5, 16, v5

    v_lshlrev_b32 v6, 16, v42
    v_add_f32 v8, v5, v6
    v_cvt_pk_bf16_f32 v4, v69, v85
    v_lshlrev_b32 v5, 16, v4
    v_and_b32 v6, 0xffff0000, v4
    v_mul_f32 v7, 0xbfb8aa3b, v6
    v_exp_f32 v7, v7
    s_nop 0
    v_add_f32 v7, 1.0, v7
    v_rcp_f32 v7, v7
    s_nop 0
    v_mul_f32 v6, v6, v7
    v_cvt_pk_bf16_f32 v6, v6, v6
    v_lshlrev_b32 v6, 16, v6
    v_mul_f32 v5, v5, v6
    v_cvt_pk_bf16_f32 v5, v5, v5
    v_lshlrev_b32 v5, 16, v5

    v_and_b32 v6, 0xffff0000, v42
    v_add_f32 v9, v5, v6
    v_cvt_pk_bf16_f32 v4, v70, v86
    v_lshlrev_b32 v5, 16, v4
    v_and_b32 v6, 0xffff0000, v4
    v_mul_f32 v7, 0xbfb8aa3b, v6
    v_exp_f32 v7, v7
    s_nop 0
    v_add_f32 v7, 1.0, v7
    v_rcp_f32 v7, v7
    s_nop 0
    v_mul_f32 v6, v6, v7
    v_cvt_pk_bf16_f32 v6, v6, v6
    v_lshlrev_b32 v6, 16, v6
    v_mul_f32 v5, v5, v6
    v_cvt_pk_bf16_f32 v5, v5, v5
    v_lshlrev_b32 v5, 16, v5

    v_lshlrev_b32 v6, 16, v43
    v_add_f32 v10, v5, v6
    v_cvt_pk_bf16_f32 v4, v71, v87
    v_lshlrev_b32 v5, 16, v4
    v_and_b32 v6, 0xffff0000, v4
    v_mul_f32 v7, 0xbfb8aa3b, v6
    v_exp_f32 v7, v7
    s_nop 0
    v_add_f32 v7, 1.0, v7
    v_rcp_f32 v7, v7
    s_nop 0
    v_mul_f32 v6, v6, v7
    v_cvt_pk_bf16_f32 v6, v6, v6
    v_lshlrev_b32 v6, 16, v6
    v_mul_f32 v5, v5, v6
    v_cvt_pk_bf16_f32 v5, v5, v5
    v_lshlrev_b32 v5, 16, v5

    v_and_b32 v6, 0xffff0000, v43
    v_add_f32 v11, v5, v6
    v_cvt_pk_bf16_f32 v20, v8, v9
    v_cvt_pk_bf16_f32 v21, v10, v11
    buffer_store_dwordx2 v[20:21], v3, s[12:15], 0 offen offset:16
    v_cvt_pk_bf16_f32 v4, v72, v88
    v_lshlrev_b32 v5, 16, v4
    v_and_b32 v6, 0xffff0000, v4
    v_mul_f32 v7, 0xbfb8aa3b, v6
    v_exp_f32 v7, v7
    s_nop 0
    v_add_f32 v7, 1.0, v7
    v_rcp_f32 v7, v7
    s_nop 0
    v_mul_f32 v6, v6, v7
    v_cvt_pk_bf16_f32 v6, v6, v6
    v_lshlrev_b32 v6, 16, v6
    v_mul_f32 v5, v5, v6
    v_cvt_pk_bf16_f32 v5, v5, v5
    v_lshlrev_b32 v5, 16, v5

    v_lshlrev_b32 v6, 16, v44
    v_add_f32 v8, v5, v6
    v_cvt_pk_bf16_f32 v4, v73, v89
    v_lshlrev_b32 v5, 16, v4
    v_and_b32 v6, 0xffff0000, v4
    v_mul_f32 v7, 0xbfb8aa3b, v6
    v_exp_f32 v7, v7
    s_nop 0
    v_add_f32 v7, 1.0, v7
    v_rcp_f32 v7, v7
    s_nop 0
    v_mul_f32 v6, v6, v7
    v_cvt_pk_bf16_f32 v6, v6, v6
    v_lshlrev_b32 v6, 16, v6
    v_mul_f32 v5, v5, v6
    v_cvt_pk_bf16_f32 v5, v5, v5
    v_lshlrev_b32 v5, 16, v5

    v_and_b32 v6, 0xffff0000, v44
    v_add_f32 v9, v5, v6
    v_cvt_pk_bf16_f32 v4, v74, v90
    v_lshlrev_b32 v5, 16, v4
    v_and_b32 v6, 0xffff0000, v4
    v_mul_f32 v7, 0xbfb8aa3b, v6
    v_exp_f32 v7, v7
    s_nop 0
    v_add_f32 v7, 1.0, v7
    v_rcp_f32 v7, v7
    s_nop 0
    v_mul_f32 v6, v6, v7
    v_cvt_pk_bf16_f32 v6, v6, v6
    v_lshlrev_b32 v6, 16, v6
    v_mul_f32 v5, v5, v6
    v_cvt_pk_bf16_f32 v5, v5, v5
    v_lshlrev_b32 v5, 16, v5

    v_lshlrev_b32 v6, 16, v45
    v_add_f32 v10, v5, v6
    v_cvt_pk_bf16_f32 v4, v75, v91
    v_lshlrev_b32 v5, 16, v4
    v_and_b32 v6, 0xffff0000, v4
    v_mul_f32 v7, 0xbfb8aa3b, v6
    v_exp_f32 v7, v7
    s_nop 0
    v_add_f32 v7, 1.0, v7
    v_rcp_f32 v7, v7
    s_nop 0
    v_mul_f32 v6, v6, v7
    v_cvt_pk_bf16_f32 v6, v6, v6
    v_lshlrev_b32 v6, 16, v6
    v_mul_f32 v5, v5, v6
    v_cvt_pk_bf16_f32 v5, v5, v5
    v_lshlrev_b32 v5, 16, v5

    v_and_b32 v6, 0xffff0000, v45
    v_add_f32 v11, v5, v6
    v_cvt_pk_bf16_f32 v20, v8, v9
    v_cvt_pk_bf16_f32 v21, v10, v11
    buffer_store_dwordx2 v[20:21], v3, s[12:15], 0 offen offset:32
    v_cvt_pk_bf16_f32 v4, v76, v92
    v_lshlrev_b32 v5, 16, v4
    v_and_b32 v6, 0xffff0000, v4
    v_mul_f32 v7, 0xbfb8aa3b, v6
    v_exp_f32 v7, v7
    s_nop 0
    v_add_f32 v7, 1.0, v7
    v_rcp_f32 v7, v7
    s_nop 0
    v_mul_f32 v6, v6, v7
    v_cvt_pk_bf16_f32 v6, v6, v6
    v_lshlrev_b32 v6, 16, v6
    v_mul_f32 v5, v5, v6
    v_cvt_pk_bf16_f32 v5, v5, v5
    v_lshlrev_b32 v5, 16, v5

    v_lshlrev_b32 v6, 16, v46
    v_add_f32 v8, v5, v6
    v_cvt_pk_bf16_f32 v4, v77, v93
    v_lshlrev_b32 v5, 16, v4
    v_and_b32 v6, 0xffff0000, v4
    v_mul_f32 v7, 0xbfb8aa3b, v6
    v_exp_f32 v7, v7
    s_nop 0
    v_add_f32 v7, 1.0, v7
    v_rcp_f32 v7, v7
    s_nop 0
    v_mul_f32 v6, v6, v7
    v_cvt_pk_bf16_f32 v6, v6, v6
    v_lshlrev_b32 v6, 16, v6
    v_mul_f32 v5, v5, v6
    v_cvt_pk_bf16_f32 v5, v5, v5
    v_lshlrev_b32 v5, 16, v5

    v_and_b32 v6, 0xffff0000, v46
    v_add_f32 v9, v5, v6
    v_cvt_pk_bf16_f32 v4, v78, v94
    v_lshlrev_b32 v5, 16, v4
    v_and_b32 v6, 0xffff0000, v4
    v_mul_f32 v7, 0xbfb8aa3b, v6
    v_exp_f32 v7, v7
    s_nop 0
    v_add_f32 v7, 1.0, v7
    v_rcp_f32 v7, v7
    s_nop 0
    v_mul_f32 v6, v6, v7
    v_cvt_pk_bf16_f32 v6, v6, v6
    v_lshlrev_b32 v6, 16, v6
    v_mul_f32 v5, v5, v6
    v_cvt_pk_bf16_f32 v5, v5, v5
    v_lshlrev_b32 v5, 16, v5

    v_lshlrev_b32 v6, 16, v47
    v_add_f32 v10, v5, v6
    v_cvt_pk_bf16_f32 v4, v79, v95
    v_lshlrev_b32 v5, 16, v4
    v_and_b32 v6, 0xffff0000, v4
    v_mul_f32 v7, 0xbfb8aa3b, v6
    v_exp_f32 v7, v7
    s_nop 0
    v_add_f32 v7, 1.0, v7
    v_rcp_f32 v7, v7
    s_nop 0
    v_mul_f32 v6, v6, v7
    v_cvt_pk_bf16_f32 v6, v6, v6
    v_lshlrev_b32 v6, 16, v6
    v_mul_f32 v5, v5, v6
    v_cvt_pk_bf16_f32 v5, v5, v5
    v_lshlrev_b32 v5, 16, v5

    v_and_b32 v6, 0xffff0000, v47
    v_add_f32 v11, v5, v6
    v_cvt_pk_bf16_f32 v20, v8, v9
    v_cvt_pk_bf16_f32 v21, v10, v11
    buffer_store_dwordx2 v[20:21], v3, s[12:15], 0 offen offset:48
ok_done:
    s_endpgm
.section .rodata,"a"
.p2align 6
.amdhsa_kernel ln_kernel
  .amdhsa_next_free_vgpr 32
  .amdhsa_next_free_sgpr 24
  .amdhsa_accum_offset 32
  .amdhsa_group_segment_fixed_size 0
  .amdhsa_kernarg_size 104
  .amdhsa_user_sgpr_count 2
  .amdhsa_user_sgpr_kernarg_segment_ptr 1
  .amdhsa_system_sgpr_workgroup_id_x 1
.end_amdhsa_kernel

.section .rodata,"a"
.p2align 6
.amdhsa_kernel proj_kernel
  .amdhsa_next_free_vgpr 248
  .amdhsa_next_free_sgpr 64
  .amdhsa_accum_offset 248
  .amdhsa_group_segment_fixed_size 0
  .amdhsa_kernarg_size 104
  .amdhsa_user_sgpr_count 2
  .amdhsa_user_sgpr_kernarg_segment_ptr 1
  .amdhsa_system_sgpr_workgroup_id_x 1
.end_amdhsa_kernel

.section .rodata,"a"
.p2align 6
.amdhsa_kernel attn_kernel
  .amdhsa_next_free_vgpr 352
  .amdhsa_next_free_sgpr 64
  .amdhsa_accum_offset 256
  .amdhsa_group_segment_fixed_size 0
  .amdhsa_kernarg_size 104
  .amdhsa_user_sgpr_count 2
  .amdhsa_user_sgpr_kernarg_segment_ptr 1
  .amdhsa_system_sgpr_workgroup_id_x 1
.end_amdhsa_kernel

.section .rodata,"a"
.p2align 6
.amdhsa_kernel out_kernel
  .amdhsa_next_free_vgpr 96
  .amdhsa_next_free_sgpr 64
  .amdhsa_accum_offset 96
  .amdhsa_group_segment_fixed_size 0
  .amdhsa_kernarg_size 104
  .amdhsa_user_sgpr_count 2
  .amdhsa_user_sgpr_kernarg_segment_ptr 1
  .amdhsa_system_sgpr_workgroup_id_x 1
.end_amdhsa_kernel
```
